```python
import torch

def _softmax(x, axis=-1):
    return torch.softmax(x, dim=axis)

def _gelu(x):
    return torch.nn.functional.gelu(x, approximate='tanh')

def _silu(x):
    return torch.nn.functional.silu(x)

def _sigmoid(x):
    return torch.sigmoid(x)

def _layernorm(x, axis=-1, eps=1e-05):
    m = x.mean(dim=axis, keepdim=True)
    v = x.var(dim=axis, keepdim=True, unbiased=False)
    return (x - m) / torch.sqrt(v + eps)

def _scatter_add(tgt, idx, src, axis=0):
    return tgt.clone().index_add_(axis, idx, src)

def _segment_sum(src, seg, n):
    out = torch.zeros((n,) + src.shape[1:], dtype=src.dtype)
    return out.index_add_(0, seg, src)

def _pad(x, pw):
    flat = tuple((v for pair in reversed(pw) for v in pair))
    return torch.nn.functional.pad(x, flat)
kernel_name = 'standalone__tree_speculative_verify_tree_attention_over_candidate_token_tree__sampling'

def setup_inputs():

    _w = lambda a: (lambda t: t.to(torch.bfloat16) if t.is_floating_point() else t)(torch.as_tensor(a))
    B, Hq, Hkv, T, C, D = (32, 32, 4, 32, 2048, 128)
    tree_mask = torch.zeros((B, T, T), dtype=float)
    for b in range(B):
        parent = torch.zeros(T, dtype=torch.int64)
        for i in range(1, T):
            parent[i] = int(torch.randint(0, i, (1,)).item())
        for i in range(T):
            j = i
            tree_mask[b, i, j] = 1.0
            while j > 0:
                j = parent[j]
                tree_mask[b, i, j] = 1.0
    return {'q': _w((lambda *s: torch.randn(*s, dtype=torch.bfloat16) * 0.8)(B, Hq, T, D)), 'k_cache': _w((lambda *s: torch.randn(*s, dtype=torch.bfloat16) * 0.8)(B, Hkv, C, D)), 'v_cache': _w((lambda *s: torch.randn(*s, dtype=torch.bfloat16) * 0.05)(B, Hkv, C, D)), 'k_tree': _w((lambda *s: torch.randn(*s, dtype=torch.bfloat16) * 0.8)(B, Hkv, T, D)), 'v_tree': _w((lambda *s: torch.randn(*s, dtype=torch.bfloat16) * 0.05)(B, Hkv, T, D)), 'tree_mask': _w(tree_mask)}

def reference(q, k_cache, v_cache, k_tree, v_tree, tree_mask):
    B, Hq, T, D = q.shape
    Hkv, C = (k_cache.shape[1], k_cache.shape[2])
    rep = Hq // Hkv
    kc = (lambda x, n, axis: torch.repeat_interleave(x, n, dim=axis))(k_cache, rep, axis=1)
    vc = (lambda x, n, axis: torch.repeat_interleave(x, n, dim=axis))(v_cache, rep, axis=1)
    kt = (lambda x, n, axis: torch.repeat_interleave(x, n, dim=axis))(k_tree, rep, axis=1)
    vt = (lambda x, n, axis: torch.repeat_interleave(x, n, dim=axis))(v_tree, rep, axis=1)
    k = torch.concatenate([kc, kt], axis=2)
    v = torch.concatenate([vc, vt], axis=2)
    scale = D ** (-0.5)
    scores = torch.einsum('bhqd,bhkd->bhqk', q, k) * scale
    ctx_mask = torch.ones((B, 1, T, C), dtype=scores.dtype)
    tm = tree_mask[:, None, :, :].clone()
    full_mask = torch.concatenate([ctx_mask, tm], axis=-1)
    scores = scores + (1.0 - full_mask) * -1000000000.0
    p = _softmax(scores, axis=-1)
    return torch.einsum('bhqk,bhkd->bhqd', p, v)
```

```asm
; @launch grid=(256,1,1) block=(256,1,1) lds=163840
.amdgcn_target "amdgcn-amd-amdhsa--gfx950"
.text
.globl standalone__tree_speculative_verify_tree_attention_over_candidate_token_tree__sampling_kernel
.p2align 8
.type standalone__tree_speculative_verify_tree_attention_over_candidate_token_tree__sampling_kernel,@function
standalone__tree_speculative_verify_tree_attention_over_candidate_token_tree__sampling_kernel:
  s_cmp_ge_u32 s2, 256
  s_cbranch_scc1 L_done
  s_load_dwordx8 s[4:11], s[0:1], 0
  s_load_dwordx4 s[12:15], s[0:1], 32
  s_load_dwordx2 s[16:17], s[0:1], 48
  s_getpc_b64 s[70:71]
L_pcbase:
  v_lshrrev_b32 v1, 6, v0
  v_and_b32 v222, 63, v0
  v_lshlrev_b32 v13, 4, v0
  s_cmp_ge_u32 s2, 32
  s_cbranch_scc1 L_nopf
  s_mov_b32 s3, L_codeend-L_pcbase-16
  v_min_u32 v12, s3, v13
  global_load_dwordx4 v[24:27], v12, s[70:71]
  v_add_u32 v13, 0x1000, v13
  v_min_u32 v12, s3, v13
  global_load_dwordx4 v[24:27], v12, s[70:71]
  v_add_u32 v13, 0x1000, v13
  v_min_u32 v12, s3, v13
  global_load_dwordx4 v[24:27], v12, s[70:71]
  v_add_u32 v13, 0x1000, v13
  v_min_u32 v12, s3, v13
  global_load_dwordx4 v[24:27], v12, s[70:71]
  v_add_u32 v13, 0x1000, v13
  v_min_u32 v12, s3, v13
  global_load_dwordx4 v[24:27], v12, s[70:71]
  v_add_u32 v13, 0x1000, v13
  v_min_u32 v12, s3, v13
  global_load_dwordx4 v[24:27], v12, s[70:71]
  v_add_u32 v13, 0x1000, v13
L_nopf:
  s_and_b32 s3, s2, 7
  v_readfirstlane_b32 s48, v1
  s_lshr_b32 s66, s2, 4
  s_lshl_b32 s66, s66, 3
  s_add_u32 s66, s66, s3
  s_lshr_b32 s67, s2, 3
  s_and_b32 s67, s67, 1
  s_lshr_b32 s49, s48, 1
  s_and_b32 s50, s48, 1
  s_lshl_b32 s53, s48, 12
  v_lshrrev_b32 v1, 4, v222
  v_and_b32 v2, 15, v222
  v_lshlrev_b32 v3, 8, v1
  v_add_u32 v3, s53, v3
  v_add_u32 v4, 0, v1
  v_xor_b32 v4, v4, v2
  v_lshl_add_u32 v236, v4, 4, v3
  v_add_u32 v4, 4, v1
  v_xor_b32 v4, v4, v2
  v_lshl_add_u32 v237, v4, 4, v3
  v_add_u32 v4, 8, v1
  v_xor_b32 v4, v4, v2
  v_lshl_add_u32 v238, v4, 4, v3
  v_add_u32 v4, 12, v1
  v_xor_b32 v4, v4, v2
  v_lshl_add_u32 v239, v4, 4, v3
  v_add_u32 v4, 0, v1
  v_lshlrev_b32 v4, 1, v4
  v_xor_b32 v4, v4, v2
  v_lshl_add_u32 v240, v4, 4, v3
  v_add_u32 v4, 4, v1
  v_lshlrev_b32 v4, 1, v4
  v_xor_b32 v4, v4, v2
  v_lshl_add_u32 v241, v4, 4, v3
  v_lshlrev_b32 v7, 6, v2
  v_lshl_add_u32 v7, v1, 3, v7
  v_lshlrev_b32 v14, 4, v222
  s_lshl_b32 s62, s66, 16
  s_lshl_b32 s63, s67, 15
  s_add_u32 s62, s62, s63
  s_lshl_b32 s63, s66, 19
  s_lshr_b32 s64, s66, 2
  s_lshl_b32 s64, s64, 11
  s_lshl_b32 s65, s48, 13
  s_mov_b32 s51, 0
  s_mov_b32 s52, 0
  s_waitcnt lgkmcnt(0)
  s_add_u32 s28, s4, s62
  s_addc_u32 s29, s5, 0
  s_mov_b32 s30, 32768
  s_mov_b32 s31, 0x00020000
  buffer_load_dwordx4 v[128:131], v14, s[28:31], s65 offen offset:0 nt
  buffer_load_dwordx4 v[132:135], v14, s[28:31], s65 offen offset:1024 nt
  buffer_load_dwordx4 v[136:139], v14, s[28:31], s65 offen offset:2048 nt
  buffer_load_dwordx4 v[140:143], v14, s[28:31], s65 offen offset:3072 nt
  s_add_u32 s65, s65, 4096
  s_add_u32 s20, s6, s63
  s_addc_u32 s21, s7, 0
  s_mov_b32 s22, 524288
  s_mov_b32 s23, 0x00020000
  buffer_load_dwordx4 v[144:147], v14, s[28:31], s65 offen offset:0 nt
  buffer_load_dwordx4 v[148:151], v14, s[28:31], s65 offen offset:1024 nt
  buffer_load_dwordx4 v[152:155], v14, s[28:31], s65 offen offset:2048 nt
  buffer_load_dwordx4 v[156:159], v14, s[28:31], s65 offen offset:3072 nt
  s_add_u32 m0, s53, 0
  s_nop 0
  buffer_load_dwordx4 v236, s[20:23], s51 offen offset:0 nt lds
  buffer_load_dwordx4 v237, s[20:23], s51 offen offset:1024 nt lds
  buffer_load_dwordx4 v238, s[20:23], s51 offen offset:2048 nt lds
  buffer_load_dwordx4 v239, s[20:23], s51 offen offset:3072 nt lds
  s_add_u32 s51, s51, 16384
  s_add_u32 s40, s14, s64
  s_addc_u32 s41, s15, 0
  s_mov_b32 s42, 2048
  s_mov_b32 s43, 0x00020000
  buffer_load_dwordx2 v[16:17], v7, s[40:43], 0 offen offset:0
  buffer_load_dwordx2 v[18:19], v7, s[40:43], 0 offen offset:32
  buffer_load_dwordx2 v[20:21], v7, s[40:43], 0 offen offset:1024
  buffer_load_dwordx2 v[22:23], v7, s[40:43], 0 offen offset:1056
  s_add_u32 s24, s8, s63
  s_addc_u32 s25, s9, 0
  s_mov_b32 s26, 524288
  s_mov_b32 s27, 0x00020000
  s_lshl_b32 s63, s66, 13
  s_add_u32 s32, s10, s63
  s_addc_u32 s33, s11, 0
  s_mov_b32 s34, 8192
  s_mov_b32 s35, 0x00020000
  s_add_u32 s36, s12, s63
  s_addc_u32 s37, s13, 0
  s_mov_b32 s38, 8192
  s_mov_b32 s39, 0x00020000
  s_add_u32 s44, s16, s62
  s_addc_u32 s45, s17, 0
  s_mov_b32 s46, 32768
  s_mov_b32 s47, 0x00020000
  s_lshl_b32 s59, s48, 11
  s_lshl_b32 s64, s50, 3
  v_lshlrev_b32 v8, 8, v1
  v_add_u32 v8, s59, v8
  v_add_u32 v9, s64, v1
  v_add_u32 v9, 0, v9
  v_xor_b32 v9, v9, v2
  v_lshl_add_u32 v15, v9, 4, v8
  v_subrev_u32 v12, s59, v240
  v_add_u32 v9, s64, v1
  v_add_u32 v9, 4, v9
  v_xor_b32 v9, v9, v2
  v_lshl_add_u32 v13, v9, 4, v8
  v_subrev_u32 v11, s59, v241
  s_mov_b32 s65, 0
  s_lshl_b32 s64, s50, 13
  v_lshlrev_b32 v8, 8, v2
  v_add_u32 v8, s64, v8
  v_add_u32 v10, 0, v1
  v_xor_b32 v10, v10, v2
  v_lshl_add_u32 v224, v10, 4, v8
  v_add_u32 v10, 4, v1
  v_xor_b32 v10, v10, v2
  v_lshl_add_u32 v225, v10, 4, v8
  v_add_u32 v10, 8, v1
  v_xor_b32 v10, v10, v2
  v_lshl_add_u32 v226, v10, 4, v8
  v_add_u32 v10, 12, v1
  v_xor_b32 v10, v10, v2
  v_lshl_add_u32 v227, v10, 4, v8
  v_lshrrev_b32 v9, 2, v2
  v_lshl_add_u32 v10, v1, 2, v9
  v_and_b32 v5, 7, v10
  v_lshlrev_b32 v10, 8, v10
  s_add_u32 s64, s64, 65536
  v_add_u32 v10, s64, v10
  v_and_b32 v6, 3, v2
  v_lshl_add_u32 v10, v6, 3, v10
  v_xor_b32 v6, 0, v5
  v_lshl_add_u32 v228, v6, 5, v10
  v_xor_b32 v6, 1, v5
  v_lshl_add_u32 v229, v6, 5, v10
  v_xor_b32 v6, 2, v5
  v_lshl_add_u32 v230, v6, 5, v10
  v_xor_b32 v6, 3, v5
  v_lshl_add_u32 v231, v6, 5, v10
  v_xor_b32 v6, 4, v5
  v_lshl_add_u32 v232, v6, 5, v10
  v_xor_b32 v6, 5, v5
  v_lshl_add_u32 v233, v6, 5, v10
  v_xor_b32 v6, 6, v5
  v_lshl_add_u32 v234, v6, 5, v10
  v_xor_b32 v6, 7, v5
  v_lshl_add_u32 v235, v6, 5, v10
  v_mov_b32 v64, 0
  v_mov_b32 v65, 0
  v_mov_b32 v66, 0
  v_mov_b32 v67, 0
  v_mov_b32 v68, 0
  v_mov_b32 v69, 0
  v_mov_b32 v70, 0
  v_mov_b32 v71, 0
  v_mov_b32 v72, 0
  v_mov_b32 v73, 0
  v_mov_b32 v74, 0
  v_mov_b32 v75, 0
  v_mov_b32 v76, 0
  v_mov_b32 v77, 0
  v_mov_b32 v78, 0
  v_mov_b32 v79, 0
  v_mov_b32 v80, 0
  v_mov_b32 v81, 0
  v_mov_b32 v82, 0
  v_mov_b32 v83, 0
  v_mov_b32 v84, 0
  v_mov_b32 v85, 0
  v_mov_b32 v86, 0
  v_mov_b32 v87, 0
  v_mov_b32 v88, 0
  v_mov_b32 v89, 0
  v_mov_b32 v90, 0
  v_mov_b32 v91, 0
  v_mov_b32 v92, 0
  v_mov_b32 v93, 0
  v_mov_b32 v94, 0
  v_mov_b32 v95, 0
  v_mov_b32 v96, 0
  v_mov_b32 v97, 0
  v_mov_b32 v98, 0
  v_mov_b32 v99, 0
  v_mov_b32 v100, 0
  v_mov_b32 v101, 0
  v_mov_b32 v102, 0
  v_mov_b32 v103, 0
  v_mov_b32 v104, 0
  v_mov_b32 v105, 0
  v_mov_b32 v106, 0
  v_mov_b32 v107, 0
  v_mov_b32 v108, 0
  v_mov_b32 v109, 0
  v_mov_b32 v110, 0
  v_mov_b32 v111, 0
  v_mov_b32 v112, 0
  v_mov_b32 v113, 0
  v_mov_b32 v114, 0
  v_mov_b32 v115, 0
  v_mov_b32 v116, 0
  v_mov_b32 v117, 0
  v_mov_b32 v118, 0
  v_mov_b32 v119, 0
  v_mov_b32 v120, 0
  v_mov_b32 v121, 0
  v_mov_b32 v122, 0
  v_mov_b32 v123, 0
  v_mov_b32 v124, 0
  v_mov_b32 v125, 0
  v_mov_b32 v126, 0
  v_mov_b32 v127, 0
  v_accvgpr_write_b32 a0, 0
  v_accvgpr_write_b32 a1, 0
  v_accvgpr_write_b32 a2, 0
  v_accvgpr_write_b32 a3, 0
  v_accvgpr_write_b32 a4, 0
  v_accvgpr_write_b32 a5, 0
  v_accvgpr_write_b32 a6, 0
  v_accvgpr_write_b32 a7, 0
  v_accvgpr_write_b32 a8, 0
  v_accvgpr_write_b32 a9, 0
  v_accvgpr_write_b32 a10, 0
  v_accvgpr_write_b32 a11, 0
  v_accvgpr_write_b32 a12, 0
  v_accvgpr_write_b32 a13, 0
  v_accvgpr_write_b32 a14, 0
  v_accvgpr_write_b32 a15, 0
  v_accvgpr_write_b32 a16, 0
  v_accvgpr_write_b32 a17, 0
  v_accvgpr_write_b32 a18, 0
  v_accvgpr_write_b32 a19, 0
  v_accvgpr_write_b32 a20, 0
  v_accvgpr_write_b32 a21, 0
  v_accvgpr_write_b32 a22, 0
  v_accvgpr_write_b32 a23, 0
  v_accvgpr_write_b32 a24, 0
  v_accvgpr_write_b32 a25, 0
  v_accvgpr_write_b32 a26, 0
  v_accvgpr_write_b32 a27, 0
  v_accvgpr_write_b32 a28, 0
  v_accvgpr_write_b32 a29, 0
  v_accvgpr_write_b32 a30, 0
  v_accvgpr_write_b32 a31, 0
  v_accvgpr_write_b32 a32, 0
  v_accvgpr_write_b32 a33, 0
  v_accvgpr_write_b32 a34, 0
  v_accvgpr_write_b32 a35, 0
  v_accvgpr_write_b32 a36, 0
  v_accvgpr_write_b32 a37, 0
  v_accvgpr_write_b32 a38, 0
  v_accvgpr_write_b32 a39, 0
  v_accvgpr_write_b32 a40, 0
  v_accvgpr_write_b32 a41, 0
  v_accvgpr_write_b32 a42, 0
  v_accvgpr_write_b32 a43, 0
  v_accvgpr_write_b32 a44, 0
  v_accvgpr_write_b32 a45, 0
  v_accvgpr_write_b32 a46, 0
  v_accvgpr_write_b32 a47, 0
  v_accvgpr_write_b32 a48, 0
  v_accvgpr_write_b32 a49, 0
  v_accvgpr_write_b32 a50, 0
  v_accvgpr_write_b32 a51, 0
  v_accvgpr_write_b32 a52, 0
  v_accvgpr_write_b32 a53, 0
  v_accvgpr_write_b32 a54, 0
  v_accvgpr_write_b32 a55, 0
  v_accvgpr_write_b32 a56, 0
  v_accvgpr_write_b32 a57, 0
  v_accvgpr_write_b32 a58, 0
  v_accvgpr_write_b32 a59, 0
  v_accvgpr_write_b32 a60, 0
  v_accvgpr_write_b32 a61, 0
  v_accvgpr_write_b32 a62, 0
  v_accvgpr_write_b32 a63, 0
  s_mov_b32 s55, 0x40004000
  v_mov_b32 v200, 0
  v_mov_b32 v201, 0
  v_mov_b32 v202, 0
  v_mov_b32 v203, 0
  v_mov_b32 v204, 0
  v_mov_b32 v205, 0
  v_mov_b32 v206, 0
  v_mov_b32 v207, 0
  v_mov_b32 v208, 0
  v_mov_b32 v209, 0
  v_mov_b32 v210, 0
  v_mov_b32 v211, 0
  v_mov_b32 v212, 0
  v_mov_b32 v213, 0
  v_mov_b32 v214, 0
  v_mov_b32 v215, 0
  v_mov_b32 v244, 0x3f803f80
  v_mov_b32 v245, 0x3f803f80
  v_mov_b32 v246, 0x3f803f80
  v_mov_b32 v247, 0x3f803f80
  s_mov_b32 s68, 0x3e0293ee
  s_mov_b32 s69, 0x3e0293ee
  s_lshl_b32 s63, s49, 16
  s_add_u32 s63, s63, 49152
  s_lshl_b32 s64, s50, 13
  s_add_u32 s64, s64, s63
  s_sub_u32 s64, s64, s53
  v_add_u32 v4, s64, v236
  v_add_u32 v5, s64, v237
  v_add_u32 v6, s64, v238
  v_add_u32 v7, s64, v239
  s_lshl_b32 s64, s50, 14
  s_sub_u32 s64, s63, s64
  s_add_u32 s64, s64, 8192
  v_add_u32 v48, s63, v224
  v_add_u32 v52, s64, v224
  v_add_u32 v49, s63, v225
  v_add_u32 v53, s64, v225
  v_add_u32 v50, s63, v226
  v_add_u32 v54, s64, v226
  v_add_u32 v51, s63, v227
  v_add_u32 v55, s64, v227
  s_lshl_b32 s64, s50, 13
  s_sub_u32 s63, 131072, s64
  s_sub_u32 s64, 73728, s64
  v_add_u32 v0, s63, v224
  v_add_u32 v1, s63, v225
  v_add_u32 v2, s63, v226
  v_add_u32 v3, s63, v227
  v_add_u32 v248, s64, v228
  v_add_u32 v249, s64, v229
  v_add_u32 v250, s64, v230
  v_add_u32 v251, s64, v231
  v_add_u32 v252, s64, v232
  v_add_u32 v253, s64, v233
  v_add_u32 v254, s64, v234
  v_add_u32 v255, s64, v235
  s_waitcnt vmcnt(15)
  v_lshlrev_b32 v176, 16, v128
  v_and_b32 v177, 0xffff0000, v128
  v_lshlrev_b32 v178, 16, v129
  v_and_b32 v179, 0xffff0000, v129
  v_lshlrev_b32 v180, 16, v130
  v_and_b32 v181, 0xffff0000, v130
  v_lshlrev_b32 v182, 16, v131
  v_and_b32 v183, 0xffff0000, v131
  v_pk_mul_f32 v[176:177], v[176:177], s[68:69]
  v_pk_mul_f32 v[178:179], v[178:179], s[68:69]
  v_pk_mul_f32 v[180:181], v[180:181], s[68:69]
  v_pk_mul_f32 v[182:183], v[182:183], s[68:69]
  v_cvt_pk_bf16_f32 v184, v176, v177
  v_cvt_pk_bf16_f32 v185, v178, v179
  v_cvt_pk_bf16_f32 v186, v180, v181
  v_cvt_pk_bf16_f32 v187, v182, v183
  ds_write_b128 v4, v[184:187] offset:0
  s_waitcnt vmcnt(14)
  s_add_u32 m0, s53, 65536
  s_nop 0
  buffer_load_dwordx4 v240, s[24:27], s52 offen offset:0 nt lds
  buffer_load_dwordx4 v241, s[24:27], s52 offen offset:1024 nt lds
  buffer_load_dwordx4 v240, s[24:27], s52 offen offset:2048 nt lds
  buffer_load_dwordx4 v241, s[24:27], s52 offen offset:3072 nt lds
  s_add_u32 s52, s52, 16384
  v_lshlrev_b32 v176, 16, v132
  v_and_b32 v177, 0xffff0000, v132
  v_lshlrev_b32 v178, 16, v133
  v_and_b32 v179, 0xffff0000, v133
  v_lshlrev_b32 v180, 16, v134
  v_and_b32 v181, 0xffff0000, v134
  v_lshlrev_b32 v182, 16, v135
  v_and_b32 v183, 0xffff0000, v135
  v_pk_mul_f32 v[176:177], v[176:177], s[68:69]
  v_pk_mul_f32 v[178:179], v[178:179], s[68:69]
  v_pk_mul_f32 v[180:181], v[180:181], s[68:69]
  v_pk_mul_f32 v[182:183], v[182:183], s[68:69]
  v_cvt_pk_bf16_f32 v188, v176, v177
  v_cvt_pk_bf16_f32 v189, v178, v179
  v_cvt_pk_bf16_f32 v190, v180, v181
  v_cvt_pk_bf16_f32 v191, v182, v183
  ds_write_b128 v5, v[188:191] offset:1024
  s_waitcnt vmcnt(17)
  v_lshlrev_b32 v176, 16, v136
  v_and_b32 v177, 0xffff0000, v136
  v_lshlrev_b32 v178, 16, v137
  v_and_b32 v179, 0xffff0000, v137
  v_lshlrev_b32 v180, 16, v138
  v_and_b32 v181, 0xffff0000, v138
  v_lshlrev_b32 v182, 16, v139
  v_and_b32 v183, 0xffff0000, v139
  v_pk_mul_f32 v[176:177], v[176:177], s[68:69]
  v_pk_mul_f32 v[178:179], v[178:179], s[68:69]
  v_pk_mul_f32 v[180:181], v[180:181], s[68:69]
  v_pk_mul_f32 v[182:183], v[182:183], s[68:69]
  v_cvt_pk_bf16_f32 v184, v176, v177
  v_cvt_pk_bf16_f32 v185, v178, v179
  v_cvt_pk_bf16_f32 v186, v180, v181
  v_cvt_pk_bf16_f32 v187, v182, v183
  ds_write_b128 v6, v[184:187] offset:2048
  s_waitcnt vmcnt(16)
  s_add_u32 m0, s59, 131072
  s_nop 0
  buffer_load_dwordx4 v15, s[32:35], s65 offen offset:0 nt lds
  buffer_load_dwordx4 v13, s[32:35], s65 offen offset:1024 nt lds
  v_lshlrev_b32 v176, 16, v140
  v_and_b32 v177, 0xffff0000, v140
  v_lshlrev_b32 v178, 16, v141
  v_and_b32 v179, 0xffff0000, v141
  v_lshlrev_b32 v180, 16, v142
  v_and_b32 v181, 0xffff0000, v142
  v_lshlrev_b32 v182, 16, v143
  v_and_b32 v183, 0xffff0000, v143
  v_pk_mul_f32 v[176:177], v[176:177], s[68:69]
  v_pk_mul_f32 v[178:179], v[178:179], s[68:69]
  v_pk_mul_f32 v[180:181], v[180:181], s[68:69]
  v_pk_mul_f32 v[182:183], v[182:183], s[68:69]
  v_cvt_pk_bf16_f32 v188, v176, v177
  v_cvt_pk_bf16_f32 v189, v178, v179
  v_cvt_pk_bf16_f32 v190, v180, v181
  v_cvt_pk_bf16_f32 v191, v182, v183
  ds_write_b128 v7, v[188:191] offset:3072
  s_waitcnt vmcnt(17)
  v_lshlrev_b32 v176, 16, v144
  v_and_b32 v177, 0xffff0000, v144
  v_lshlrev_b32 v178, 16, v145
  v_and_b32 v179, 0xffff0000, v145
  v_lshlrev_b32 v180, 16, v146
  v_and_b32 v181, 0xffff0000, v146
  v_lshlrev_b32 v182, 16, v147
  v_and_b32 v183, 0xffff0000, v147
  v_pk_mul_f32 v[176:177], v[176:177], s[68:69]
  v_pk_mul_f32 v[178:179], v[178:179], s[68:69]
  v_pk_mul_f32 v[180:181], v[180:181], s[68:69]
  v_pk_mul_f32 v[182:183], v[182:183], s[68:69]
  v_cvt_pk_bf16_f32 v184, v176, v177
  v_cvt_pk_bf16_f32 v185, v178, v179
  v_cvt_pk_bf16_f32 v186, v180, v181
  v_cvt_pk_bf16_f32 v187, v182, v183
  ds_write_b128 v4, v[184:187] offset:4096
  s_waitcnt vmcnt(16)
  s_add_u32 m0, s53, 16384
  s_nop 0
  buffer_load_dwordx4 v236, s[20:23], s51 offen offset:0 nt lds
  buffer_load_dwordx4 v237, s[20:23], s51 offen offset:1024 nt lds
  buffer_load_dwordx4 v238, s[20:23], s51 offen offset:2048 nt lds
  buffer_load_dwordx4 v239, s[20:23], s51 offen offset:3072 nt lds
  s_add_u32 s51, s51, 16384
  v_lshlrev_b32 v176, 16, v148
  v_and_b32 v177, 0xffff0000, v148
  v_lshlrev_b32 v178, 16, v149
  v_and_b32 v179, 0xffff0000, v149
  v_lshlrev_b32 v180, 16, v150
  v_and_b32 v181, 0xffff0000, v150
  v_lshlrev_b32 v182, 16, v151
  v_and_b32 v183, 0xffff0000, v151
  v_pk_mul_f32 v[176:177], v[176:177], s[68:69]
  v_pk_mul_f32 v[178:179], v[178:179], s[68:69]
  v_pk_mul_f32 v[180:181], v[180:181], s[68:69]
  v_pk_mul_f32 v[182:183], v[182:183], s[68:69]
  v_cvt_pk_bf16_f32 v188, v176, v177
  v_cvt_pk_bf16_f32 v189, v178, v179
  v_cvt_pk_bf16_f32 v190, v180, v181
  v_cvt_pk_bf16_f32 v191, v182, v183
  ds_write_b128 v5, v[188:191] offset:5120
  s_waitcnt vmcnt(19)
  v_lshlrev_b32 v176, 16, v152
  v_and_b32 v177, 0xffff0000, v152
  v_lshlrev_b32 v178, 16, v153
  v_and_b32 v179, 0xffff0000, v153
  v_lshlrev_b32 v180, 16, v154
  v_and_b32 v181, 0xffff0000, v154
  v_lshlrev_b32 v182, 16, v155
  v_and_b32 v183, 0xffff0000, v155
  v_pk_mul_f32 v[176:177], v[176:177], s[68:69]
  v_pk_mul_f32 v[178:179], v[178:179], s[68:69]
  v_pk_mul_f32 v[180:181], v[180:181], s[68:69]
  v_pk_mul_f32 v[182:183], v[182:183], s[68:69]
  v_cvt_pk_bf16_f32 v184, v176, v177
  v_cvt_pk_bf16_f32 v185, v178, v179
  v_cvt_pk_bf16_f32 v186, v180, v181
  v_cvt_pk_bf16_f32 v187, v182, v183
  ds_write_b128 v6, v[184:187] offset:6144
  s_waitcnt vmcnt(18)
  s_add_u32 m0, s59, 139264
  s_nop 0
  buffer_load_dwordx4 v12, s[36:39], s65 offen offset:0 nt lds
  buffer_load_dwordx4 v11, s[36:39], s65 offen offset:1024 nt lds
  v_lshlrev_b32 v176, 16, v156
  v_and_b32 v177, 0xffff0000, v156
  v_lshlrev_b32 v178, 16, v157
  v_and_b32 v179, 0xffff0000, v157
  v_lshlrev_b32 v180, 16, v158
  v_and_b32 v181, 0xffff0000, v158
  v_lshlrev_b32 v182, 16, v159
  v_and_b32 v183, 0xffff0000, v159
  v_pk_mul_f32 v[176:177], v[176:177], s[68:69]
  v_pk_mul_f32 v[178:179], v[178:179], s[68:69]
  v_pk_mul_f32 v[180:181], v[180:181], s[68:69]
  v_pk_mul_f32 v[182:183], v[182:183], s[68:69]
  v_cvt_pk_bf16_f32 v188, v176, v177
  v_cvt_pk_bf16_f32 v189, v178, v179
  v_cvt_pk_bf16_f32 v190, v180, v181
  v_cvt_pk_bf16_f32 v191, v182, v183
  ds_write_b128 v7, v[188:191] offset:7168
  s_add_u32 m0, s53, 81920
  s_nop 0
  buffer_load_dwordx4 v240, s[24:27], s52 offen offset:0 nt lds
  buffer_load_dwordx4 v241, s[24:27], s52 offen offset:1024 nt lds
  buffer_load_dwordx4 v240, s[24:27], s52 offen offset:2048 nt lds
  buffer_load_dwordx4 v241, s[24:27], s52 offen offset:3072 nt lds
  s_add_u32 s52, s52, 16384
  s_waitcnt vmcnt(16) lgkmcnt(0)
  s_barrier
  ds_read_b128 a[64:67], v48
  ds_read_b128 a[128:131], v224 offset:0
  ds_read_b128 a[68:71], v49
  ds_read_b128 a[132:135], v225 offset:0
  ds_read_b128 a[72:75], v50
  ds_read_b128 a[136:139], v226 offset:0
  ds_read_b128 a[76:79], v51
  ds_read_b128 a[140:143], v227 offset:0
  ds_read_b128 a[144:147], v224 offset:4096
  ds_read_b128 a[148:151], v225 offset:4096
  ds_read_b128 a[152:155], v226 offset:4096
  ds_read_b128 a[156:159], v227 offset:4096
  ds_read_b128 a[80:83], v48 offset:4096
  ds_read_b128 a[84:87], v49 offset:4096
  ds_read_b128 a[88:91], v50 offset:4096
  ds_read_b128 a[92:95], v51 offset:4096
  ds_read_b128 a[96:99], v52 offset:0
  ds_read_b128 a[100:103], v53 offset:0
  ds_read_b128 a[104:107], v54 offset:0
  ds_read_b128 a[108:111], v55 offset:0
  ds_read_b128 a[112:115], v52 offset:4096
  ds_read_b128 a[116:119], v53 offset:4096
  ds_read_b128 a[120:123], v54 offset:4096
  ds_read_b128 a[124:127], v55 offset:4096
  s_mov_b32 s62, 0xceabfb8f
  v_lshlrev_b32 v32, 16, v16
  v_and_b32 v33, 0xffff0000, v16
  v_lshlrev_b32 v34, 16, v17
  v_and_b32 v35, 0xffff0000, v17
  v_lshlrev_b32 v36, 16, v18
  v_and_b32 v37, 0xffff0000, v18
  v_lshlrev_b32 v38, 16, v19
  v_and_b32 v39, 0xffff0000, v19
  v_lshlrev_b32 v40, 16, v20
  v_and_b32 v41, 0xffff0000, v20
  v_lshlrev_b32 v42, 16, v21
  v_and_b32 v43, 0xffff0000, v21
  v_lshlrev_b32 v44, 16, v22
  v_and_b32 v45, 0xffff0000, v22
  v_lshlrev_b32 v46, 16, v23
  v_and_b32 v47, 0xffff0000, v23
  s_waitcnt lgkmcnt(15)
  v_mfma_f32_16x16x32_bf16 v[128:131], a[128:131], a[64:67], 0
  v_sub_f32 v32, 1.0, v32
  v_sub_f32 v33, 1.0, v33
  s_waitcnt lgkmcnt(15)
  v_mfma_f32_16x16x32_bf16 v[128:131], a[132:135], a[68:71], v[128:131]
  v_sub_f32 v34, 1.0, v34
  v_sub_f32 v35, 1.0, v35
  s_waitcnt lgkmcnt(15)
  v_mfma_f32_16x16x32_bf16 v[128:131], a[136:139], a[72:75], v[128:131]
  v_sub_f32 v36, 1.0, v36
  v_sub_f32 v37, 1.0, v37
  s_waitcnt lgkmcnt(15)
  v_mfma_f32_16x16x32_bf16 v[128:131], a[140:143], a[76:79], v[128:131]
  v_sub_f32 v38, 1.0, v38
  v_sub_f32 v39, 1.0, v39
  s_waitcnt lgkmcnt(15)
  v_mfma_f32_16x16x32_bf16 v[132:135], a[144:147], a[64:67], 0
  v_sub_f32 v40, 1.0, v40
  v_sub_f32 v41, 1.0, v41
  s_waitcnt lgkmcnt(14)
  v_mfma_f32_16x16x32_bf16 v[132:135], a[148:151], a[68:71], v[132:135]
  v_sub_f32 v42, 1.0, v42
  v_sub_f32 v43, 1.0, v43
  s_waitcnt lgkmcnt(13)
  v_mfma_f32_16x16x32_bf16 v[132:135], a[152:155], a[72:75], v[132:135]
  v_sub_f32 v44, 1.0, v44
  v_sub_f32 v45, 1.0, v45
  s_waitcnt lgkmcnt(12)
  v_mfma_f32_16x16x32_bf16 v[132:135], a[156:159], a[76:79], v[132:135]
  v_sub_f32 v46, 1.0, v46
  v_sub_f32 v47, 1.0, v47
  s_waitcnt lgkmcnt(11)
  v_mfma_f32_16x16x32_bf16 v[136:139], a[128:131], a[80:83], 0
  s_add_u32 m0, s53, 32768
  s_waitcnt lgkmcnt(10)
  v_mfma_f32_16x16x32_bf16 v[136:139], a[132:135], a[84:87], v[136:139]
  s_nop 0
  s_waitcnt lgkmcnt(9)
  v_mfma_f32_16x16x32_bf16 v[136:139], a[136:139], a[88:91], v[136:139]
  buffer_load_dwordx4 v236, s[20:23], s51 offen offset:0 nt lds
  s_waitcnt lgkmcnt(8)
  v_mfma_f32_16x16x32_bf16 v[136:139], a[140:143], a[92:95], v[136:139]
  v_mfma_f32_16x16x32_bf16 v[140:143], a[144:147], a[80:83], 0
  buffer_load_dwordx4 v237, s[20:23], s51 offen offset:1024 nt lds
  v_mfma_f32_16x16x32_bf16 v[140:143], a[148:151], a[84:87], v[140:143]
  buffer_load_dwordx4 v238, s[20:23], s51 offen offset:2048 nt lds
  v_mfma_f32_16x16x32_bf16 v[140:143], a[152:155], a[88:91], v[140:143]
  v_mfma_f32_16x16x32_bf16 v[140:143], a[156:159], a[92:95], v[140:143]
  buffer_load_dwordx4 v239, s[20:23], s51 offen offset:3072 nt lds
  s_waitcnt lgkmcnt(4)
  v_mfma_f32_16x16x32_bf16 v[144:147], a[128:131], a[96:99], 0
  s_add_u32 s51, s51, 16384
  v_mfma_f32_16x16x32_bf16 v[144:147], a[132:135], a[100:103], v[144:147]
  v_mfma_f32_16x16x32_bf16 v[144:147], a[136:139], a[104:107], v[144:147]
  v_mfma_f32_16x16x32_bf16 v[144:147], a[140:143], a[108:111], v[144:147]
  v_max3_f32 v48, v128, v129, v130
  v_max3_f32 v51, v136, v137, v138
  v_max3_f32 v49, v131, v132, v133
  v_max3_f32 v52, v139, v140, v141
  v_mfma_f32_16x16x32_bf16 v[148:151], a[144:147], a[96:99], 0
  v_max3_f32 v48, v48, v134, v135
  v_max3_f32 v51, v51, v142, v143
  v_max_f32 v48, v48, v49
  v_mfma_f32_16x16x32_bf16 v[148:151], a[148:151], a[100:103], v[148:151]
  v_max_f32 v51, v51, v52
  v_mov_b32 v49, v48
  v_mov_b32 v52, v51
  s_nop 0
  v_mfma_f32_16x16x32_bf16 v[148:151], a[152:155], a[104:107], v[148:151]
  v_permlane16_swap_b32 v48, v49
  v_permlane16_swap_b32 v51, v52
  s_nop 0
  v_mfma_f32_16x16x32_bf16 v[148:151], a[156:159], a[108:111], v[148:151]
  v_max_f32 v48, v48, v49
  v_max_f32 v51, v51, v52
  v_mov_b32 v49, v48
  s_waitcnt lgkmcnt(0)
  v_mfma_f32_16x16x32_bf16 v[152:155], a[128:131], a[112:115], 0
  v_mov_b32 v52, v51
  s_nop 0
  v_permlane32_swap_b32 v48, v49
  v_permlane32_swap_b32 v51, v52
  v_mfma_f32_16x16x32_bf16 v[152:155], a[132:135], a[116:119], v[152:155]
  s_nop 0
  v_max_f32 v48, v48, v49
  v_max_f32 v51, v51, v52
  v_mfma_f32_16x16x32_bf16 v[152:155], a[136:139], a[120:123], v[152:155]
  v_add_f32 v216, 0x41200000, v48
  v_add_f32 v217, 0x41200000, v51
  v_sub_f32 v54, 0, v216
  v_sub_f32 v55, 0, v217
  v_mfma_f32_16x16x32_bf16 v[152:155], a[140:143], a[124:127], v[152:155]
  v_fma_f32 v32, v32, s62, v54
  v_fma_f32 v33, v33, s62, v54
  v_fma_f32 v34, v34, s62, v54
  v_mfma_f32_16x16x32_bf16 v[156:159], a[144:147], a[112:115], 0
  v_fma_f32 v35, v35, s62, v54
  v_fma_f32 v36, v36, s62, v54
  v_fma_f32 v37, v37, s62, v54
  v_mfma_f32_16x16x32_bf16 v[156:159], a[148:151], a[116:119], v[156:159]
  v_fma_f32 v38, v38, s62, v54
  v_fma_f32 v39, v39, s62, v54
  v_fma_f32 v40, v40, s62, v55
  v_fma_f32 v41, v41, s62, v55
  v_mfma_f32_16x16x32_bf16 v[156:159], a[152:155], a[120:123], v[156:159]
  v_fma_f32 v42, v42, s62, v55
  v_fma_f32 v43, v43, s62, v55
  v_fma_f32 v44, v44, s62, v55
  v_mfma_f32_16x16x32_bf16 v[156:159], a[156:159], a[124:127], v[156:159]
  v_fma_f32 v45, v45, s62, v55
  v_fma_f32 v46, v46, s62, v55
  v_fma_f32 v47, v47, s62, v55
  s_waitcnt vmcnt(8)
  s_barrier
  ds_read_b128 a[224:227], v0 offset:0
  ds_read_b128 a[228:231], v1 offset:0
  ds_read_b128 a[232:235], v2 offset:0
  ds_read_b128 a[236:239], v3 offset:0
  ds_read_b128 a[240:243], v0 offset:4096
  ds_read_b128 a[244:247], v1 offset:4096
  ds_read_b128 a[248:251], v2 offset:4096
  ds_read_b128 a[252:255], v3 offset:4096
  ds_read_b64_tr_b16 a[160:161], v228 offset:0
  ds_read_b64_tr_b16 a[162:163], v228 offset:4096
  ds_read_b64_tr_b16 a[164:165], v229 offset:0
  ds_read_b64_tr_b16 a[166:167], v229 offset:4096
  ds_read_b64_tr_b16 a[168:169], v230 offset:0
  ds_read_b64_tr_b16 a[170:171], v230 offset:4096
  ds_read_b64_tr_b16 a[172:173], v231 offset:0
  ds_read_b64_tr_b16 a[174:175], v231 offset:4096
  ds_read_b64_tr_b16 a[176:177], v232 offset:0
  ds_read_b64_tr_b16 a[178:179], v232 offset:4096
  ds_read_b64_tr_b16 a[180:181], v233 offset:0
  ds_read_b64_tr_b16 a[182:183], v233 offset:4096
  ds_read_b64_tr_b16 a[184:185], v234 offset:0
  ds_read_b64_tr_b16 a[186:187], v234 offset:4096
  ds_read_b64_tr_b16 a[188:189], v235 offset:0
  ds_read_b64_tr_b16 a[190:191], v235 offset:4096
  v_sub_f32 v128, v128, v216
  v_sub_f32 v129, v129, v216
  v_sub_f32 v130, v130, v216
  v_sub_f32 v131, v131, v216
  v_sub_f32 v132, v132, v216
  v_sub_f32 v133, v133, v216
  v_sub_f32 v134, v134, v216
  v_sub_f32 v135, v135, v216
  v_sub_f32 v136, v136, v217
  v_sub_f32 v137, v137, v217
  v_sub_f32 v138, v138, v217
  v_sub_f32 v139, v139, v217
  v_sub_f32 v140, v140, v217
  v_sub_f32 v141, v141, v217
  v_sub_f32 v142, v142, v217
  v_sub_f32 v143, v143, v217
  s_waitcnt lgkmcnt(15)
  v_mfma_f32_16x16x32_bf16 v[32:35], a[224:227], a[64:67], v[32:35]
  v_exp_f32 v192, v128
  v_mov_b32 v160, v54
  v_exp_f32 v193, v129
  ds_read_b64_tr_b16 a[192:193], v248 offset:0
  s_add_u32 m0, s53, 98304
  v_mfma_f32_16x16x32_bf16 v[32:35], a[228:231], a[68:71], v[32:35]
  v_mov_b32 v161, v54
  v_exp_f32 v194, v130
  ds_read_b64_tr_b16 a[194:195], v248 offset:4096
  s_nop 0
  v_mfma_f32_16x16x32_bf16 v[32:35], a[232:235], a[72:75], v[32:35]
  v_mov_b32 v162, v54
  v_cvt_pk_bf16_f32 v176, v192, v193
  ds_read_b64_tr_b16 a[196:197], v249 offset:0
  buffer_load_dwordx4 v240, s[24:27], s52 offen offset:0 nt lds
  v_mfma_f32_16x16x32_bf16 v[32:35], a[236:239], a[76:79], v[32:35]
  v_exp_f32 v195, v131
  v_mov_b32 v163, v54
  ds_read_b64_tr_b16 a[198:199], v249 offset:4096
  buffer_load_dwordx4 v241, s[24:27], s52 offen offset:1024 nt lds
  v_mfma_f32_16x16x32_bf16 v[36:39], a[240:243], a[64:67], v[36:39]
  v_exp_f32 v192, v132
  v_mov_b32 v164, v55
  ds_read_b64_tr_b16 a[200:201], v250 offset:0
  buffer_load_dwordx4 v240, s[24:27], s52 offen offset:2048 nt lds
  v_mfma_f32_16x16x32_bf16 v[36:39], a[244:247], a[68:71], v[36:39]
  v_cvt_pk_bf16_f32 v177, v194, v195
  v_exp_f32 v193, v133
  ds_read_b64_tr_b16 a[202:203], v250 offset:4096
  v_mfma_f32_16x16x32_bf16 v[36:39], a[248:251], a[72:75], v[36:39]
  v_mov_b32 v165, v55
  v_exp_f32 v194, v134
  ds_read_b64_tr_b16 a[204:205], v251 offset:0
  buffer_load_dwordx4 v241, s[24:27], s52 offen offset:3072 nt lds
  v_mfma_f32_16x16x32_bf16 v[36:39], a[252:255], a[76:79], v[36:39]
  v_mov_b32 v166, v55
  v_cvt_pk_bf16_f32 v178, v192, v193
  ds_read_b64_tr_b16 a[206:207], v251 offset:4096
  s_add_u32 s52, s52, 16384
  v_mfma_f32_16x16x32_bf16 v[40:43], a[224:227], a[80:83], v[40:43]
  v_exp_f32 v195, v135
  v_mov_b32 v167, v55
  ds_read_b64_tr_b16 a[208:209], v252 offset:0
  s_add_u32 m0, s53, 49152
  v_mfma_f32_16x16x32_bf16 v[40:43], a[228:231], a[84:87], v[40:43]
  v_exp_f32 v192, v136
  v_cvt_pk_bf16_f32 v179, v194, v195
  ds_read_b64_tr_b16 a[210:211], v252 offset:4096
  s_nop 0
  v_mfma_f32_16x16x32_bf16 v[40:43], a[232:235], a[88:91], v[40:43]
  v_exp_f32 v193, v137
  v_exp_f32 v194, v138
  ds_read_b64_tr_b16 a[212:213], v253 offset:0
  buffer_load_dwordx4 v236, s[20:23], s51 offen offset:0 nt lds
  v_mfma_f32_16x16x32_bf16 v[40:43], a[236:239], a[92:95], v[40:43]
  v_cvt_pk_bf16_f32 v180, v192, v193
  v_exp_f32 v195, v139
  ds_read_b64_tr_b16 a[214:215], v253 offset:4096
  v_mfma_f32_16x16x32_bf16 v[44:47], a[240:243], a[80:83], v[44:47]
  v_exp_f32 v192, v140
  v_cvt_pk_bf16_f32 v181, v194, v195
  ds_read_b64_tr_b16 a[216:217], v254 offset:0
  buffer_load_dwordx4 v237, s[20:23], s51 offen offset:1024 nt lds
  v_mfma_f32_16x16x32_bf16 v[44:47], a[244:247], a[84:87], v[44:47]
  v_exp_f32 v193, v141
  v_exp_f32 v194, v142
  ds_read_b64_tr_b16 a[218:219], v254 offset:4096
  buffer_load_dwordx4 v238, s[20:23], s51 offen offset:2048 nt lds
  v_mfma_f32_16x16x32_bf16 v[44:47], a[248:251], a[88:91], v[44:47]
  v_cvt_pk_bf16_f32 v182, v192, v193
  v_exp_f32 v195, v143
  ds_read_b64_tr_b16 a[220:221], v255 offset:0
  buffer_load_dwordx4 v239, s[20:23], s51 offen offset:3072 nt lds
  v_mfma_f32_16x16x32_bf16 v[44:47], a[252:255], a[92:95], v[44:47]
  s_nop 0
  v_cvt_pk_bf16_f32 v183, v194, v195
  ds_read_b64_tr_b16 a[222:223], v255 offset:4096
  s_add_u32 s51, s51, 16384
  s_waitcnt lgkmcnt(15)
  s_nop 1
  v_mfma_f32_16x16x32_bf16 v[64:67], a[160:163], v[176:179], v[64:67]
  v_max3_f32 v56, v144, v145, v146
  v_max3_f32 v59, v152, v153, v154
  v_max3_f32 v57, v147, v148, v149
  v_max3_f32 v60, v155, v156, v157
  ds_read_b128 a[224:227], v224 offset:16384
  v_mfma_f32_16x16x32_bf16 v[68:71], a[164:167], v[176:179], v[68:71]
  v_max3_f32 v56, v56, v150, v151
  v_max3_f32 v59, v59, v158, v159
  v_max_f32 v56, v56, v57
  s_add_u32 m0, s53, 0
  v_mfma_f32_16x16x32_bf16 v[72:75], a[168:171], v[176:179], v[72:75]
  v_max_f32 v59, v59, v60
  v_mov_b32 v57, v56
  v_mov_b32 v60, v59
  s_nop 0
  ds_read_b128 a[228:231], v225 offset:16384
  s_nop 0
  v_mfma_f32_16x16x32_bf16 v[76:79], a[172:175], v[176:179], v[76:79]
  v_permlane16_swap_b32 v56, v57
  v_permlane16_swap_b32 v59, v60
  s_nop 0
  buffer_load_dwordx4 v236, s[20:23], s51 offen offset:0 nt lds
  v_mfma_f32_16x16x32_bf16 v[80:83], a[176:179], v[176:179], v[80:83]
  v_max_f32 v56, v56, v57
  v_max_f32 v59, v59, v60
  v_mov_b32 v57, v56
  v_mov_b32 v60, v59
  ds_read_b128 a[232:235], v226 offset:16384
  buffer_load_dwordx4 v237, s[20:23], s51 offen offset:1024 nt lds
  v_mfma_f32_16x16x32_bf16 v[84:87], a[180:183], v[176:179], v[84:87]
  s_nop 0
  v_permlane32_swap_b32 v56, v57
  v_permlane32_swap_b32 v59, v60
  buffer_load_dwordx4 v238, s[20:23], s51 offen offset:2048 nt lds
  v_mfma_f32_16x16x32_bf16 v[88:91], a[184:187], v[176:179], v[88:91]
  s_nop 0
  v_max_f32 v56, v56, v57
  v_max_f32 v59, v59, v60
  v_add_f32 v218, 0x41200000, v56
  ds_read_b128 a[236:239], v227 offset:16384
  v_mfma_f32_16x16x32_bf16 v[92:95], a[188:191], v[176:179], v[92:95]
  v_add_f32 v219, 0x41200000, v59
  v_sub_f32 v62, 0, v218
  v_sub_f32 v63, 0, v219
  buffer_load_dwordx4 v239, s[20:23], s51 offen offset:3072 nt lds
  v_mfma_f32_16x16x32_bf16 v[200:203], v[244:247], v[176:179], v[200:203]
  v_exp_f32 v192, v32
  v_exp_f32 v193, v33
  ds_read_b128 a[240:243], v224 offset:20480
  s_add_u32 s51, s51, 16384
  v_mfma_f32_16x16x32_bf16 v[96:99], a[160:163], v[180:183], v[96:99]
  s_nop 0
  v_cvt_pk_bf16_f32 v176, v192, v193
  s_add_u32 m0, s53, 114688
  v_mfma_f32_16x16x32_bf16 v[100:103], a[164:167], v[180:183], v[100:103]
  v_exp_f32 v194, v34
  v_exp_f32 v195, v35
  ds_read_b128 a[244:247], v225 offset:20480
  s_nop 0
  v_mfma_f32_16x16x32_bf16 v[104:107], a[168:171], v[180:183], v[104:107]
  s_nop 0
  v_cvt_pk_bf16_f32 v177, v194, v195
  buffer_load_dwordx4 v240, s[24:27], s52 offen offset:0 nt lds
  v_mfma_f32_16x16x32_bf16 v[108:111], a[172:175], v[180:183], v[108:111]
  v_exp_f32 v192, v36
  ds_read_b128 a[248:251], v226 offset:20480
  v_mfma_f32_16x16x32_bf16 v[112:115], a[176:179], v[180:183], v[112:115]
  v_exp_f32 v193, v37
  s_nop 0
  buffer_load_dwordx4 v241, s[24:27], s52 offen offset:1024 nt lds
  v_mfma_f32_16x16x32_bf16 v[116:119], a[180:183], v[180:183], v[116:119]
  v_cvt_pk_bf16_f32 v178, v192, v193
  v_exp_f32 v194, v38
  ds_read_b128 a[252:255], v227 offset:20480
  buffer_load_dwordx4 v240, s[24:27], s52 offen offset:2048 nt lds
  v_mfma_f32_16x16x32_bf16 v[120:123], a[184:187], v[180:183], v[120:123]
  v_or3_b32 v220, v176, v177, v178
  v_exp_f32 v195, v39
  buffer_load_dwordx4 v241, s[24:27], s52 offen offset:3072 nt lds
  v_mfma_f32_16x16x32_bf16 v[124:127], a[188:191], v[180:183], v[124:127]
  s_nop 0
  v_cvt_pk_bf16_f32 v179, v194, v195
  s_add_u32 s52, s52, 16384
  v_mfma_f32_16x16x32_bf16 v[204:207], v[244:247], v[180:183], v[204:207]
  v_exp_f32 v192, v40
  v_exp_f32 v193, v41
  s_nop 0
  v_cvt_pk_bf16_f32 v180, v192, v193
  v_exp_f32 v194, v42
  v_or3_b32 v220, v220, v179, v180
  v_exp_f32 v195, v43
  s_nop 0
  v_cvt_pk_bf16_f32 v181, v194, v195
  v_exp_f32 v192, v44
  v_exp_f32 v193, v45
  s_nop 0
  v_cvt_pk_bf16_f32 v182, v192, v193
  v_exp_f32 v194, v46
  v_or3_b32 v220, v220, v181, v182
  v_exp_f32 v195, v47
  s_nop 0
  v_cvt_pk_bf16_f32 v183, v194, v195
  v_bitop3_b32 v220, v220, v183, s55 bitop3:0xa8
  v_cmp_ne_u32 vcc, 0, v220
  s_cbranch_vccnz L_stub1
L_back1:
  s_waitcnt lgkmcnt(0)
  v_mfma_f32_16x16x32_bf16 v[128:131], a[224:227], a[64:67], v[160:163]
  v_sub_f32 v144, v144, v218
  v_sub_f32 v145, v145, v218
  v_mfma_f32_16x16x32_bf16 v[128:131], a[228:231], a[68:71], v[128:131]
  v_sub_f32 v146, v146, v218
  v_sub_f32 v147, v147, v218
  v_mfma_f32_16x16x32_bf16 v[128:131], a[232:235], a[72:75], v[128:131]
  v_sub_f32 v148, v148, v218
  v_mfma_f32_16x16x32_bf16 v[128:131], a[236:239], a[76:79], v[128:131]
  v_sub_f32 v149, v149, v218
  v_sub_f32 v150, v150, v218
  v_mfma_f32_16x16x32_bf16 v[132:135], a[240:243], a[64:67], v[160:163]
  v_sub_f32 v151, v151, v218
  v_sub_f32 v152, v152, v219
  v_mfma_f32_16x16x32_bf16 v[132:135], a[244:247], a[68:71], v[132:135]
  s_waitcnt vmcnt(16) lgkmcnt(0)
  s_barrier
  v_sub_f32 v153, v153, v219
  v_mfma_f32_16x16x32_bf16 v[132:135], a[248:251], a[72:75], v[132:135]
  s_add_u32 m0, s53, 16384
  v_sub_f32 v154, v154, v219
  v_sub_f32 v155, v155, v219
  v_mfma_f32_16x16x32_bf16 v[132:135], a[252:255], a[76:79], v[132:135]
  buffer_load_dwordx4 v236, s[20:23], s51 offen offset:0 nt lds
  v_sub_f32 v156, v156, v219
  v_sub_f32 v157, v157, v219
  ds_read_b128 a[128:131], v224 offset:32768
  v_mfma_f32_16x16x32_bf16 v[136:139], a[224:227], a[80:83], v[164:167]
  v_sub_f32 v158, v158, v219
  v_mfma_f32_16x16x32_bf16 v[136:139], a[228:231], a[84:87], v[136:139]
  buffer_load_dwordx4 v237, s[20:23], s51 offen offset:1024 nt lds
  v_sub_f32 v159, v159, v219
  v_exp_f32 v196, v144
  ds_read_b128 a[132:135], v225 offset:32768
  v_mfma_f32_16x16x32_bf16 v[136:139], a[232:235], a[88:91], v[136:139]
  v_mov_b32 v168, v62
  v_mfma_f32_16x16x32_bf16 v[136:139], a[236:239], a[92:95], v[136:139]
  buffer_load_dwordx4 v238, s[20:23], s51 offen offset:2048 nt lds
  v_exp_f32 v197, v145
  v_mov_b32 v169, v62
  ds_read_b128 a[136:139], v226 offset:32768
  v_mfma_f32_16x16x32_bf16 v[140:143], a[240:243], a[80:83], v[164:167]
  v_exp_f32 v198, v146
  v_mov_b32 v170, v62
  v_mfma_f32_16x16x32_bf16 v[140:143], a[244:247], a[84:87], v[140:143]
  buffer_load_dwordx4 v239, s[20:23], s51 offen offset:3072 nt lds
  v_cvt_pk_bf16_f32 v184, v196, v197
  v_mfma_f32_16x16x32_bf16 v[140:143], a[248:251], a[88:91], v[140:143]
  s_add_u32 m0, s53, 65536
  s_add_u32 s51, s51, 16384
  v_exp_f32 v199, v147
  v_mov_b32 v171, v62
  v_mfma_f32_16x16x32_bf16 v[140:143], a[252:255], a[92:95], v[140:143]
  buffer_load_dwordx4 v240, s[24:27], s52 offen offset:0 nt lds
  v_exp_f32 v196, v148
  v_mov_b32 v172, v63
  ds_read_b128 a[140:143], v227 offset:32768
  v_mfma_f32_16x16x32_bf16 v[64:67], a[192:195], v[176:179], v[64:67]
  v_cvt_pk_bf16_f32 v185, v198, v199
  v_mfma_f32_16x16x32_bf16 v[68:71], a[196:199], v[176:179], v[68:71]
  buffer_load_dwordx4 v241, s[24:27], s52 offen offset:1024 nt lds
  v_exp_f32 v197, v149
  v_mov_b32 v173, v63
  ds_read_b128 a[144:147], v224 offset:36864
  v_mfma_f32_16x16x32_bf16 v[72:75], a[200:203], v[176:179], v[72:75]
  v_exp_f32 v198, v150
  v_mov_b32 v174, v63
  v_mfma_f32_16x16x32_bf16 v[76:79], a[204:207], v[176:179], v[76:79]
  buffer_load_dwordx4 v240, s[24:27], s52 offen offset:2048 nt lds
  v_cvt_pk_bf16_f32 v186, v196, v197
  ds_read_b128 a[148:151], v225 offset:36864
  v_mfma_f32_16x16x32_bf16 v[80:83], a[208:211], v[176:179], v[80:83]
  buffer_load_dwordx4 v241, s[24:27], s52 offen offset:3072 nt lds
  v_exp_f32 v199, v151
  v_mov_b32 v175, v63
  v_mfma_f32_16x16x32_bf16 v[84:87], a[212:215], v[176:179], v[84:87]
  s_add_u32 s52, s52, 16384
  v_exp_f32 v196, v152
  ds_read_b128 a[152:155], v226 offset:36864
  v_mfma_f32_16x16x32_bf16 v[88:91], a[216:219], v[176:179], v[88:91]
  v_cvt_pk_bf16_f32 v187, v198, v199
  v_exp_f32 v197, v153
  v_exp_f32 v192, v128
  v_mfma_f32_16x16x32_bf16 v[92:95], a[220:223], v[176:179], v[92:95]
  v_exp_f32 v198, v154
  v_cvt_pk_bf16_f32 v188, v196, v197
  ds_read_b128 a[156:159], v227 offset:36864
  v_mfma_f32_16x16x32_bf16 v[200:203], v[244:247], v[176:179], v[200:203]
  v_exp_f32 v199, v155
  v_exp_f32 v193, v129
  v_mfma_f32_16x16x32_bf16 v[96:99], a[192:195], v[180:183], v[96:99]
  v_exp_f32 v196, v156
  v_cvt_pk_bf16_f32 v189, v198, v199
  v_cvt_pk_bf16_f32 v176, v192, v193
  v_mfma_f32_16x16x32_bf16 v[100:103], a[196:199], v[180:183], v[100:103]
  v_exp_f32 v197, v157
  v_exp_f32 v198, v158
  v_exp_f32 v194, v130
  v_mfma_f32_16x16x32_bf16 v[104:107], a[200:203], v[180:183], v[104:107]
  v_cvt_pk_bf16_f32 v190, v196, v197
  v_mfma_f32_16x16x32_bf16 v[108:111], a[204:207], v[180:183], v[108:111]
  v_exp_f32 v199, v159
  s_nop 0
  v_exp_f32 v195, v131
  v_mfma_f32_16x16x32_bf16 v[112:115], a[208:211], v[180:183], v[112:115]
  v_cvt_pk_bf16_f32 v191, v198, v199
  v_cvt_pk_bf16_f32 v177, v194, v195
  ds_read_b64_tr_b16 a[192:193], v228 offset:16384
  v_mfma_f32_16x16x32_bf16 v[116:119], a[212:215], v[180:183], v[116:119]
  v_exp_f32 v192, v132
  v_mfma_f32_16x16x32_bf16 v[120:123], a[216:219], v[180:183], v[120:123]
  v_mfma_f32_16x16x32_bf16 v[124:127], a[220:223], v[180:183], v[124:127]
  v_exp_f32 v193, v133
  v_mfma_f32_16x16x32_bf16 v[204:207], v[244:247], v[180:183], v[204:207]
  v_cvt_pk_bf16_f32 v178, v192, v193
  ds_read_b64_tr_b16 a[194:195], v228 offset:20480
  v_mfma_f32_16x16x32_bf16 v[144:147], a[224:227], a[96:99], v[168:171]
  v_exp_f32 v194, v134
  v_mfma_f32_16x16x32_bf16 v[144:147], a[228:231], a[100:103], v[144:147]
  v_or3_b32 v220, v176, v177, v178
  ds_read_b64_tr_b16 a[196:197], v229 offset:16384
  v_mfma_f32_16x16x32_bf16 v[144:147], a[232:235], a[104:107], v[144:147]
  v_exp_f32 v195, v135
  v_mfma_f32_16x16x32_bf16 v[144:147], a[236:239], a[108:111], v[144:147]
  v_cvt_pk_bf16_f32 v179, v194, v195
  ds_read_b64_tr_b16 a[198:199], v229 offset:20480
  v_mfma_f32_16x16x32_bf16 v[148:151], a[240:243], a[96:99], v[168:171]
  v_exp_f32 v192, v136
  v_mfma_f32_16x16x32_bf16 v[148:151], a[244:247], a[100:103], v[148:151]
  v_mfma_f32_16x16x32_bf16 v[148:151], a[248:251], a[104:107], v[148:151]
  v_exp_f32 v193, v137
  v_mfma_f32_16x16x32_bf16 v[148:151], a[252:255], a[108:111], v[148:151]
  v_cvt_pk_bf16_f32 v180, v192, v193
  ds_read_b64_tr_b16 a[200:201], v230 offset:16384
  v_mfma_f32_16x16x32_bf16 v[152:155], a[224:227], a[112:115], v[172:175]
  v_exp_f32 v194, v138
  v_mfma_f32_16x16x32_bf16 v[152:155], a[228:231], a[116:119], v[152:155]
  v_or3_b32 v220, v220, v179, v180
  ds_read_b64_tr_b16 a[202:203], v230 offset:20480
  v_mfma_f32_16x16x32_bf16 v[152:155], a[232:235], a[120:123], v[152:155]
  v_exp_f32 v195, v139
  v_mfma_f32_16x16x32_bf16 v[152:155], a[236:239], a[124:127], v[152:155]
  v_cvt_pk_bf16_f32 v181, v194, v195
  ds_read_b64_tr_b16 a[204:205], v231 offset:16384
  v_mfma_f32_16x16x32_bf16 v[156:159], a[240:243], a[112:115], v[172:175]
  v_exp_f32 v192, v140
  v_mfma_f32_16x16x32_bf16 v[156:159], a[244:247], a[116:119], v[156:159]
  v_mfma_f32_16x16x32_bf16 v[156:159], a[248:251], a[120:123], v[156:159]
  v_exp_f32 v193, v141
  v_mfma_f32_16x16x32_bf16 v[156:159], a[252:255], a[124:127], v[156:159]
  v_cvt_pk_bf16_f32 v182, v192, v193
  ds_read_b64_tr_b16 a[206:207], v231 offset:20480
  v_mfma_f32_16x16x32_bf16 a[0:3], a[160:163], v[184:187], a[0:3]
  v_exp_f32 v194, v142
  v_mfma_f32_16x16x32_bf16 a[4:7], a[164:167], v[184:187], a[4:7]
  v_or3_b32 v220, v220, v181, v182
  ds_read_b64_tr_b16 a[208:209], v232 offset:16384
  v_mfma_f32_16x16x32_bf16 a[8:11], a[168:171], v[184:187], a[8:11]
  v_exp_f32 v195, v143
  v_mfma_f32_16x16x32_bf16 a[12:15], a[172:175], v[184:187], a[12:15]
  v_cvt_pk_bf16_f32 v183, v194, v195
  ds_read_b64_tr_b16 a[210:211], v232 offset:20480
  v_mfma_f32_16x16x32_bf16 a[16:19], a[176:179], v[184:187], a[16:19]
  v_mfma_f32_16x16x32_bf16 a[20:23], a[180:183], v[184:187], a[20:23]
  v_bitop3_b32 v220, v220, v183, s55 bitop3:0xa8
  ds_read_b64_tr_b16 a[212:213], v233 offset:16384
  v_mfma_f32_16x16x32_bf16 a[24:27], a[184:187], v[184:187], a[24:27]
  v_exp_f32 v196, v144
  v_mfma_f32_16x16x32_bf16 a[28:31], a[188:191], v[184:187], a[28:31]
  v_cmp_ne_u32 vcc, 0, v220
  ds_read_b64_tr_b16 a[214:215], v233 offset:20480
  v_mfma_f32_16x16x32_bf16 v[208:211], v[244:247], v[184:187], v[208:211]
  v_exp_f32 v197, v145
  v_mfma_f32_16x16x32_bf16 a[32:35], a[160:163], v[188:191], a[32:35]
  s_cbranch_vccnz L_stub2
L_back2:
  v_cvt_pk_bf16_f32 v184, v196, v197
  ds_read_b64_tr_b16 a[216:217], v234 offset:16384
  v_mfma_f32_16x16x32_bf16 a[36:39], a[164:167], v[188:191], a[36:39]
  v_exp_f32 v198, v146
  v_mfma_f32_16x16x32_bf16 a[40:43], a[168:171], v[188:191], a[40:43]
  ds_read_b64_tr_b16 a[218:219], v234 offset:20480
  ds_read_b64_tr_b16 a[220:221], v235 offset:16384
  v_mfma_f32_16x16x32_bf16 a[44:47], a[172:175], v[188:191], a[44:47]
  v_exp_f32 v199, v147
  v_mfma_f32_16x16x32_bf16 a[48:51], a[176:179], v[188:191], a[48:51]
  v_cvt_pk_bf16_f32 v185, v198, v199
  ds_read_b64_tr_b16 a[222:223], v235 offset:20480
  v_mfma_f32_16x16x32_bf16 a[52:55], a[180:183], v[188:191], a[52:55]
  v_exp_f32 v196, v148
  v_mfma_f32_16x16x32_bf16 a[56:59], a[184:187], v[188:191], a[56:59]
  v_mfma_f32_16x16x32_bf16 a[60:63], a[188:191], v[188:191], a[60:63]
  v_exp_f32 v197, v149
  v_mfma_f32_16x16x32_bf16 v[212:215], v[244:247], v[188:191], v[212:215]
  v_cvt_pk_bf16_f32 v186, v196, v197
  s_waitcnt lgkmcnt(15)
  v_mfma_f32_16x16x32_bf16 v[128:131], a[128:131], a[64:67], v[160:163]
  v_exp_f32 v198, v150
  v_mfma_f32_16x16x32_bf16 v[128:131], a[132:135], a[68:71], v[128:131]
  v_or3_b32 v221, v184, v185, v186
  v_mfma_f32_16x16x32_bf16 v[128:131], a[136:139], a[72:75], v[128:131]
  v_exp_f32 v199, v151
  v_mfma_f32_16x16x32_bf16 v[128:131], a[140:143], a[76:79], v[128:131]
  v_cvt_pk_bf16_f32 v187, v198, v199
  v_mfma_f32_16x16x32_bf16 v[132:135], a[144:147], a[64:67], v[160:163]
  v_exp_f32 v196, v152
  v_mfma_f32_16x16x32_bf16 v[132:135], a[148:151], a[68:71], v[132:135]
  s_waitcnt vmcnt(16) lgkmcnt(0)
  s_barrier
  v_mfma_f32_16x16x32_bf16 v[132:135], a[152:155], a[72:75], v[132:135]
  s_add_u32 m0, s53, 32768
  v_exp_f32 v197, v153
  v_mfma_f32_16x16x32_bf16 v[132:135], a[156:159], a[76:79], v[132:135]
  buffer_load_dwordx4 v236, s[20:23], s51 offen offset:0 nt lds
  v_cvt_pk_bf16_f32 v188, v196, v197
  ds_read_b128 a[224:227], v224 offset:49152
  v_mfma_f32_16x16x32_bf16 v[136:139], a[128:131], a[80:83], v[164:167]
  v_exp_f32 v198, v154
  v_mfma_f32_16x16x32_bf16 v[136:139], a[132:135], a[84:87], v[136:139]
  buffer_load_dwordx4 v237, s[20:23], s51 offen offset:1024 nt lds
  v_or3_b32 v221, v221, v187, v188
  ds_read_b128 a[228:231], v225 offset:49152
  v_mfma_f32_16x16x32_bf16 v[136:139], a[136:139], a[88:91], v[136:139]
  v_exp_f32 v199, v155
  v_mfma_f32_16x16x32_bf16 v[136:139], a[140:143], a[92:95], v[136:139]
  buffer_load_dwordx4 v238, s[20:23], s51 offen offset:2048 nt lds
  v_cvt_pk_bf16_f32 v189, v198, v199
  ds_read_b128 a[232:235], v226 offset:49152
  v_mfma_f32_16x16x32_bf16 v[140:143], a[144:147], a[80:83], v[164:167]
  v_exp_f32 v196, v156
  v_mfma_f32_16x16x32_bf16 v[140:143], a[148:151], a[84:87], v[140:143]
  buffer_load_dwordx4 v239, s[20:23], s51 offen offset:3072 nt lds
  v_mfma_f32_16x16x32_bf16 v[140:143], a[152:155], a[88:91], v[140:143]
  s_add_u32 m0, s53, 81920
  s_add_u32 s51, s51, 16384
  v_exp_f32 v197, v157
  v_mfma_f32_16x16x32_bf16 v[140:143], a[156:159], a[92:95], v[140:143]
  buffer_load_dwordx4 v240, s[24:27], s52 offen offset:0 nt lds
  v_cvt_pk_bf16_f32 v190, v196, v197
  ds_read_b128 a[236:239], v227 offset:49152
  v_mfma_f32_16x16x32_bf16 v[64:67], a[192:195], v[176:179], v[64:67]
  v_exp_f32 v198, v158
  v_mfma_f32_16x16x32_bf16 v[68:71], a[196:199], v[176:179], v[68:71]
  buffer_load_dwordx4 v241, s[24:27], s52 offen offset:1024 nt lds
  v_or3_b32 v221, v221, v189, v190
  ds_read_b128 a[240:243], v224 offset:53248
  v_mfma_f32_16x16x32_bf16 v[72:75], a[200:203], v[176:179], v[72:75]
  v_exp_f32 v199, v159
  v_mfma_f32_16x16x32_bf16 v[76:79], a[204:207], v[176:179], v[76:79]
  buffer_load_dwordx4 v240, s[24:27], s52 offen offset:2048 nt lds
  v_cvt_pk_bf16_f32 v191, v198, v199
  ds_read_b128 a[244:247], v225 offset:53248
  v_mfma_f32_16x16x32_bf16 v[80:83], a[208:211], v[176:179], v[80:83]
  buffer_load_dwordx4 v241, s[24:27], s52 offen offset:3072 nt lds
  v_mfma_f32_16x16x32_bf16 v[84:87], a[212:215], v[176:179], v[84:87]
  s_add_u32 s52, s52, 16384
  v_bitop3_b32 v221, v221, v191, s55 bitop3:0xa8
  ds_read_b128 a[248:251], v226 offset:53248
  v_mfma_f32_16x16x32_bf16 v[88:91], a[216:219], v[176:179], v[88:91]
  v_exp_f32 v192, v128
  v_mfma_f32_16x16x32_bf16 v[92:95], a[220:223], v[176:179], v[92:95]
  v_cmp_ne_u32 vcc, 0, v221
  ds_read_b128 a[252:255], v227 offset:53248
  v_mfma_f32_16x16x32_bf16 v[200:203], v[244:247], v[176:179], v[200:203]
  v_exp_f32 v193, v129
  v_mfma_f32_16x16x32_bf16 v[96:99], a[192:195], v[180:183], v[96:99]
  s_cbranch_vccnz L_stub3
L_back3:
  v_cvt_pk_bf16_f32 v176, v192, v193
  v_mfma_f32_16x16x32_bf16 v[100:103], a[196:199], v[180:183], v[100:103]
  v_exp_f32 v194, v130
  v_mfma_f32_16x16x32_bf16 v[104:107], a[200:203], v[180:183], v[104:107]
  v_mfma_f32_16x16x32_bf16 v[108:111], a[204:207], v[180:183], v[108:111]
  v_exp_f32 v195, v131
  v_mfma_f32_16x16x32_bf16 v[112:115], a[208:211], v[180:183], v[112:115]
  v_cvt_pk_bf16_f32 v177, v194, v195
  ds_read_b64_tr_b16 a[160:161], v228 offset:32768
  v_mfma_f32_16x16x32_bf16 v[116:119], a[212:215], v[180:183], v[116:119]
  v_exp_f32 v192, v132
  v_mfma_f32_16x16x32_bf16 v[120:123], a[216:219], v[180:183], v[120:123]
  v_mfma_f32_16x16x32_bf16 v[124:127], a[220:223], v[180:183], v[124:127]
  v_exp_f32 v193, v133
  v_mfma_f32_16x16x32_bf16 v[204:207], v[244:247], v[180:183], v[204:207]
  v_cvt_pk_bf16_f32 v178, v192, v193
  ds_read_b64_tr_b16 a[162:163], v228 offset:36864
  v_mfma_f32_16x16x32_bf16 v[144:147], a[128:131], a[96:99], v[168:171]
  v_exp_f32 v194, v134
  v_mfma_f32_16x16x32_bf16 v[144:147], a[132:135], a[100:103], v[144:147]
  v_or3_b32 v220, v176, v177, v178
  ds_read_b64_tr_b16 a[164:165], v229 offset:32768
  v_mfma_f32_16x16x32_bf16 v[144:147], a[136:139], a[104:107], v[144:147]
  v_exp_f32 v195, v135
  v_mfma_f32_16x16x32_bf16 v[144:147], a[140:143], a[108:111], v[144:147]
  v_cvt_pk_bf16_f32 v179, v194, v195
  ds_read_b64_tr_b16 a[166:167], v229 offset:36864
  v_mfma_f32_16x16x32_bf16 v[148:151], a[144:147], a[96:99], v[168:171]
  v_exp_f32 v192, v136
  v_mfma_f32_16x16x32_bf16 v[148:151], a[148:151], a[100:103], v[148:151]
  v_mfma_f32_16x16x32_bf16 v[148:151], a[152:155], a[104:107], v[148:151]
  v_exp_f32 v193, v137
  v_mfma_f32_16x16x32_bf16 v[148:151], a[156:159], a[108:111], v[148:151]
  v_cvt_pk_bf16_f32 v180, v192, v193
  ds_read_b64_tr_b16 a[168:169], v230 offset:32768
  v_mfma_f32_16x16x32_bf16 v[152:155], a[128:131], a[112:115], v[172:175]
  v_exp_f32 v194, v138
  v_mfma_f32_16x16x32_bf16 v[152:155], a[132:135], a[116:119], v[152:155]
  v_or3_b32 v220, v220, v179, v180
  ds_read_b64_tr_b16 a[170:171], v230 offset:36864
  v_mfma_f32_16x16x32_bf16 v[152:155], a[136:139], a[120:123], v[152:155]
  v_exp_f32 v195, v139
  v_mfma_f32_16x16x32_bf16 v[152:155], a[140:143], a[124:127], v[152:155]
  v_cvt_pk_bf16_f32 v181, v194, v195
  ds_read_b64_tr_b16 a[172:173], v231 offset:32768
  v_mfma_f32_16x16x32_bf16 v[156:159], a[144:147], a[112:115], v[172:175]
  v_exp_f32 v192, v140
  v_mfma_f32_16x16x32_bf16 v[156:159], a[148:151], a[116:119], v[156:159]
  v_mfma_f32_16x16x32_bf16 v[156:159], a[152:155], a[120:123], v[156:159]
  v_exp_f32 v193, v141
  v_mfma_f32_16x16x32_bf16 v[156:159], a[156:159], a[124:127], v[156:159]
  v_cvt_pk_bf16_f32 v182, v192, v193
  ds_read_b64_tr_b16 a[174:175], v231 offset:36864
  v_mfma_f32_16x16x32_bf16 a[0:3], a[192:195], v[184:187], a[0:3]
  v_exp_f32 v194, v142
  v_mfma_f32_16x16x32_bf16 a[4:7], a[196:199], v[184:187], a[4:7]
  v_or3_b32 v220, v220, v181, v182
  ds_read_b64_tr_b16 a[176:177], v232 offset:32768
  v_mfma_f32_16x16x32_bf16 a[8:11], a[200:203], v[184:187], a[8:11]
  v_exp_f32 v195, v143
  v_mfma_f32_16x16x32_bf16 a[12:15], a[204:207], v[184:187], a[12:15]
  v_cvt_pk_bf16_f32 v183, v194, v195
  ds_read_b64_tr_b16 a[178:179], v232 offset:36864
  v_mfma_f32_16x16x32_bf16 a[16:19], a[208:211], v[184:187], a[16:19]
  v_mfma_f32_16x16x32_bf16 a[20:23], a[212:215], v[184:187], a[20:23]
  v_bitop3_b32 v220, v220, v183, s55 bitop3:0xa8
  ds_read_b64_tr_b16 a[180:181], v233 offset:32768
  v_mfma_f32_16x16x32_bf16 a[24:27], a[216:219], v[184:187], a[24:27]
  v_exp_f32 v196, v144
  v_mfma_f32_16x16x32_bf16 a[28:31], a[220:223], v[184:187], a[28:31]
  v_cmp_ne_u32 vcc, 0, v220
  ds_read_b64_tr_b16 a[182:183], v233 offset:36864
  v_mfma_f32_16x16x32_bf16 v[208:211], v[244:247], v[184:187], v[208:211]
  v_exp_f32 v197, v145
  v_mfma_f32_16x16x32_bf16 a[32:35], a[192:195], v[188:191], a[32:35]
  s_cbranch_vccnz L_stub4
L_back4:
  v_cvt_pk_bf16_f32 v184, v196, v197
  ds_read_b64_tr_b16 a[184:185], v234 offset:32768
  v_mfma_f32_16x16x32_bf16 a[36:39], a[196:199], v[188:191], a[36:39]
  v_exp_f32 v198, v146
  v_mfma_f32_16x16x32_bf16 a[40:43], a[200:203], v[188:191], a[40:43]
  ds_read_b64_tr_b16 a[186:187], v234 offset:36864
  ds_read_b64_tr_b16 a[188:189], v235 offset:32768
  v_mfma_f32_16x16x32_bf16 a[44:47], a[204:207], v[188:191], a[44:47]
  v_exp_f32 v199, v147
  v_mfma_f32_16x16x32_bf16 a[48:51], a[208:211], v[188:191], a[48:51]
  v_cvt_pk_bf16_f32 v185, v198, v199
  ds_read_b64_tr_b16 a[190:191], v235 offset:36864
  v_mfma_f32_16x16x32_bf16 a[52:55], a[212:215], v[188:191], a[52:55]
  v_exp_f32 v196, v148
  v_mfma_f32_16x16x32_bf16 a[56:59], a[216:219], v[188:191], a[56:59]
  v_mfma_f32_16x16x32_bf16 a[60:63], a[220:223], v[188:191], a[60:63]
  v_exp_f32 v197, v149
  v_mfma_f32_16x16x32_bf16 v[212:215], v[244:247], v[188:191], v[212:215]
  v_cvt_pk_bf16_f32 v186, v196, v197
  s_waitcnt lgkmcnt(15)
  v_mfma_f32_16x16x32_bf16 v[128:131], a[224:227], a[64:67], v[160:163]
  v_exp_f32 v198, v150
  v_mfma_f32_16x16x32_bf16 v[128:131], a[228:231], a[68:71], v[128:131]
  v_or3_b32 v221, v184, v185, v186
  v_mfma_f32_16x16x32_bf16 v[128:131], a[232:235], a[72:75], v[128:131]
  v_exp_f32 v199, v151
  v_mfma_f32_16x16x32_bf16 v[128:131], a[236:239], a[76:79], v[128:131]
  v_cvt_pk_bf16_f32 v187, v198, v199
  v_mfma_f32_16x16x32_bf16 v[132:135], a[240:243], a[64:67], v[160:163]
  v_exp_f32 v196, v152
  v_mfma_f32_16x16x32_bf16 v[132:135], a[244:247], a[68:71], v[132:135]
  s_waitcnt vmcnt(16) lgkmcnt(0)
  s_barrier
  v_mfma_f32_16x16x32_bf16 v[132:135], a[248:251], a[72:75], v[132:135]
  s_add_u32 m0, s53, 49152
  v_exp_f32 v197, v153
  v_mfma_f32_16x16x32_bf16 v[132:135], a[252:255], a[76:79], v[132:135]
  buffer_load_dwordx4 v236, s[20:23], s51 offen offset:0 nt lds
  v_cvt_pk_bf16_f32 v188, v196, v197
  ds_read_b128 a[128:131], v224 offset:0
  v_mfma_f32_16x16x32_bf16 v[136:139], a[224:227], a[80:83], v[164:167]
  v_exp_f32 v198, v154
  v_mfma_f32_16x16x32_bf16 v[136:139], a[228:231], a[84:87], v[136:139]
  buffer_load_dwordx4 v237, s[20:23], s51 offen offset:1024 nt lds
  v_or3_b32 v221, v221, v187, v188
  ds_read_b128 a[132:135], v225 offset:0
  v_mfma_f32_16x16x32_bf16 v[136:139], a[232:235], a[88:91], v[136:139]
  v_exp_f32 v199, v155
  v_mfma_f32_16x16x32_bf16 v[136:139], a[236:239], a[92:95], v[136:139]
  buffer_load_dwordx4 v238, s[20:23], s51 offen offset:2048 nt lds
  v_cvt_pk_bf16_f32 v189, v198, v199
  ds_read_b128 a[136:139], v226 offset:0
  v_mfma_f32_16x16x32_bf16 v[140:143], a[240:243], a[80:83], v[164:167]
  v_exp_f32 v196, v156
  v_mfma_f32_16x16x32_bf16 v[140:143], a[244:247], a[84:87], v[140:143]
  buffer_load_dwordx4 v239, s[20:23], s51 offen offset:3072 nt lds
  v_mfma_f32_16x16x32_bf16 v[140:143], a[248:251], a[88:91], v[140:143]
  s_add_u32 m0, s53, 98304
  s_add_u32 s51, s51, 16384
  v_exp_f32 v197, v157
  v_mfma_f32_16x16x32_bf16 v[140:143], a[252:255], a[92:95], v[140:143]
  buffer_load_dwordx4 v240, s[24:27], s52 offen offset:0 nt lds
  v_cvt_pk_bf16_f32 v190, v196, v197
  ds_read_b128 a[140:143], v227 offset:0
  v_mfma_f32_16x16x32_bf16 v[64:67], a[160:163], v[176:179], v[64:67]
  v_exp_f32 v198, v158
  v_mfma_f32_16x16x32_bf16 v[68:71], a[164:167], v[176:179], v[68:71]
  buffer_load_dwordx4 v241, s[24:27], s52 offen offset:1024 nt lds
  v_or3_b32 v221, v221, v189, v190
  ds_read_b128 a[144:147], v224 offset:4096
  v_mfma_f32_16x16x32_bf16 v[72:75], a[168:171], v[176:179], v[72:75]
  v_exp_f32 v199, v159
  v_mfma_f32_16x16x32_bf16 v[76:79], a[172:175], v[176:179], v[76:79]
  buffer_load_dwordx4 v240, s[24:27], s52 offen offset:2048 nt lds
  v_cvt_pk_bf16_f32 v191, v198, v199
  ds_read_b128 a[148:151], v225 offset:4096
  v_mfma_f32_16x16x32_bf16 v[80:83], a[176:179], v[176:179], v[80:83]
  buffer_load_dwordx4 v241, s[24:27], s52 offen offset:3072 nt lds
  v_mfma_f32_16x16x32_bf16 v[84:87], a[180:183], v[176:179], v[84:87]
  s_add_u32 s52, s52, 16384
  v_bitop3_b32 v221, v221, v191, s55 bitop3:0xa8
  ds_read_b128 a[152:155], v226 offset:4096
  v_mfma_f32_16x16x32_bf16 v[88:91], a[184:187], v[176:179], v[88:91]
  v_exp_f32 v192, v128
  v_mfma_f32_16x16x32_bf16 v[92:95], a[188:191], v[176:179], v[92:95]
  v_cmp_ne_u32 vcc, 0, v221
  ds_read_b128 a[156:159], v227 offset:4096
  v_mfma_f32_16x16x32_bf16 v[200:203], v[244:247], v[176:179], v[200:203]
  v_exp_f32 v193, v129
  v_mfma_f32_16x16x32_bf16 v[96:99], a[160:163], v[180:183], v[96:99]
  s_cbranch_vccnz L_stub5
L_back5:
  v_cvt_pk_bf16_f32 v176, v192, v193
  v_mfma_f32_16x16x32_bf16 v[100:103], a[164:167], v[180:183], v[100:103]
  v_exp_f32 v194, v130
  v_mfma_f32_16x16x32_bf16 v[104:107], a[168:171], v[180:183], v[104:107]
  v_mfma_f32_16x16x32_bf16 v[108:111], a[172:175], v[180:183], v[108:111]
  v_exp_f32 v195, v131
  v_mfma_f32_16x16x32_bf16 v[112:115], a[176:179], v[180:183], v[112:115]
  v_cvt_pk_bf16_f32 v177, v194, v195
  ds_read_b64_tr_b16 a[192:193], v228 offset:49152
  v_mfma_f32_16x16x32_bf16 v[116:119], a[180:183], v[180:183], v[116:119]
  v_exp_f32 v192, v132
  v_mfma_f32_16x16x32_bf16 v[120:123], a[184:187], v[180:183], v[120:123]
  v_mfma_f32_16x16x32_bf16 v[124:127], a[188:191], v[180:183], v[124:127]
  v_exp_f32 v193, v133
  v_mfma_f32_16x16x32_bf16 v[204:207], v[244:247], v[180:183], v[204:207]
  v_cvt_pk_bf16_f32 v178, v192, v193
  ds_read_b64_tr_b16 a[194:195], v228 offset:53248
  v_mfma_f32_16x16x32_bf16 v[144:147], a[224:227], a[96:99], v[168:171]
  v_exp_f32 v194, v134
  v_mfma_f32_16x16x32_bf16 v[144:147], a[228:231], a[100:103], v[144:147]
  v_or3_b32 v220, v176, v177, v178
  ds_read_b64_tr_b16 a[196:197], v229 offset:49152
  v_mfma_f32_16x16x32_bf16 v[144:147], a[232:235], a[104:107], v[144:147]
  v_exp_f32 v195, v135
  v_mfma_f32_16x16x32_bf16 v[144:147], a[236:239], a[108:111], v[144:147]
  v_cvt_pk_bf16_f32 v179, v194, v195
  ds_read_b64_tr_b16 a[198:199], v229 offset:53248
  v_mfma_f32_16x16x32_bf16 v[148:151], a[240:243], a[96:99], v[168:171]
  v_exp_f32 v192, v136
  v_mfma_f32_16x16x32_bf16 v[148:151], a[244:247], a[100:103], v[148:151]
  v_mfma_f32_16x16x32_bf16 v[148:151], a[248:251], a[104:107], v[148:151]
  v_exp_f32 v193, v137
  v_mfma_f32_16x16x32_bf16 v[148:151], a[252:255], a[108:111], v[148:151]
  v_cvt_pk_bf16_f32 v180, v192, v193
  ds_read_b64_tr_b16 a[200:201], v230 offset:49152
  v_mfma_f32_16x16x32_bf16 v[152:155], a[224:227], a[112:115], v[172:175]
  v_exp_f32 v194, v138
  v_mfma_f32_16x16x32_bf16 v[152:155], a[228:231], a[116:119], v[152:155]
  v_or3_b32 v220, v220, v179, v180
  ds_read_b64_tr_b16 a[202:203], v230 offset:53248
  v_mfma_f32_16x16x32_bf16 v[152:155], a[232:235], a[120:123], v[152:155]
  v_exp_f32 v195, v139
  v_mfma_f32_16x16x32_bf16 v[152:155], a[236:239], a[124:127], v[152:155]
  v_cvt_pk_bf16_f32 v181, v194, v195
  ds_read_b64_tr_b16 a[204:205], v231 offset:49152
  v_mfma_f32_16x16x32_bf16 v[156:159], a[240:243], a[112:115], v[172:175]
  v_exp_f32 v192, v140
  v_mfma_f32_16x16x32_bf16 v[156:159], a[244:247], a[116:119], v[156:159]
  v_mfma_f32_16x16x32_bf16 v[156:159], a[248:251], a[120:123], v[156:159]
  v_exp_f32 v193, v141
  v_mfma_f32_16x16x32_bf16 v[156:159], a[252:255], a[124:127], v[156:159]
  v_cvt_pk_bf16_f32 v182, v192, v193
  ds_read_b64_tr_b16 a[206:207], v231 offset:53248
  v_mfma_f32_16x16x32_bf16 a[0:3], a[160:163], v[184:187], a[0:3]
  v_exp_f32 v194, v142
  v_mfma_f32_16x16x32_bf16 a[4:7], a[164:167], v[184:187], a[4:7]
  v_or3_b32 v220, v220, v181, v182
  ds_read_b64_tr_b16 a[208:209], v232 offset:49152
  v_mfma_f32_16x16x32_bf16 a[8:11], a[168:171], v[184:187], a[8:11]
  v_exp_f32 v195, v143
  v_mfma_f32_16x16x32_bf16 a[12:15], a[172:175], v[184:187], a[12:15]
  v_cvt_pk_bf16_f32 v183, v194, v195
  ds_read_b64_tr_b16 a[210:211], v232 offset:53248
  v_mfma_f32_16x16x32_bf16 a[16:19], a[176:179], v[184:187], a[16:19]
  v_mfma_f32_16x16x32_bf16 a[20:23], a[180:183], v[184:187], a[20:23]
  v_bitop3_b32 v220, v220, v183, s55 bitop3:0xa8
  ds_read_b64_tr_b16 a[212:213], v233 offset:49152
  v_mfma_f32_16x16x32_bf16 a[24:27], a[184:187], v[184:187], a[24:27]
  v_exp_f32 v196, v144
  v_mfma_f32_16x16x32_bf16 a[28:31], a[188:191], v[184:187], a[28:31]
  v_cmp_ne_u32 vcc, 0, v220
  ds_read_b64_tr_b16 a[214:215], v233 offset:53248
  v_mfma_f32_16x16x32_bf16 v[208:211], v[244:247], v[184:187], v[208:211]
  v_exp_f32 v197, v145
  v_mfma_f32_16x16x32_bf16 a[32:35], a[160:163], v[188:191], a[32:35]
  s_cbranch_vccnz L_stub6
L_back6:
  v_cvt_pk_bf16_f32 v184, v196, v197
  ds_read_b64_tr_b16 a[216:217], v234 offset:49152
  v_mfma_f32_16x16x32_bf16 a[36:39], a[164:167], v[188:191], a[36:39]
  v_exp_f32 v198, v146
  v_mfma_f32_16x16x32_bf16 a[40:43], a[168:171], v[188:191], a[40:43]
  ds_read_b64_tr_b16 a[218:219], v234 offset:53248
  ds_read_b64_tr_b16 a[220:221], v235 offset:49152
  v_mfma_f32_16x16x32_bf16 a[44:47], a[172:175], v[188:191], a[44:47]
  v_exp_f32 v199, v147
  v_mfma_f32_16x16x32_bf16 a[48:51], a[176:179], v[188:191], a[48:51]
  v_cvt_pk_bf16_f32 v185, v198, v199
  ds_read_b64_tr_b16 a[222:223], v235 offset:53248
  v_mfma_f32_16x16x32_bf16 a[52:55], a[180:183], v[188:191], a[52:55]
  v_exp_f32 v196, v148
  v_mfma_f32_16x16x32_bf16 a[56:59], a[184:187], v[188:191], a[56:59]
  v_mfma_f32_16x16x32_bf16 a[60:63], a[188:191], v[188:191], a[60:63]
  v_exp_f32 v197, v149
  v_mfma_f32_16x16x32_bf16 v[212:215], v[244:247], v[188:191], v[212:215]
  v_cvt_pk_bf16_f32 v186, v196, v197
  s_mov_b32 s54, 6
L_loop:
  s_waitcnt lgkmcnt(15)
  v_mfma_f32_16x16x32_bf16 v[128:131], a[128:131], a[64:67], v[160:163]
  v_exp_f32 v198, v150
  v_mfma_f32_16x16x32_bf16 v[128:131], a[132:135], a[68:71], v[128:131]
  v_or3_b32 v221, v184, v185, v186
  v_mfma_f32_16x16x32_bf16 v[128:131], a[136:139], a[72:75], v[128:131]
  v_exp_f32 v199, v151
  v_mfma_f32_16x16x32_bf16 v[128:131], a[140:143], a[76:79], v[128:131]
  v_cvt_pk_bf16_f32 v187, v198, v199
  v_mfma_f32_16x16x32_bf16 v[132:135], a[144:147], a[64:67], v[160:163]
  v_exp_f32 v196, v152
  v_mfma_f32_16x16x32_bf16 v[132:135], a[148:151], a[68:71], v[132:135]
  s_waitcnt vmcnt(16) lgkmcnt(0)
  s_barrier
  v_mfma_f32_16x16x32_bf16 v[132:135], a[152:155], a[72:75], v[132:135]
  v_exp_f32 v197, v153
  v_mfma_f32_16x16x32_bf16 v[132:135], a[156:159], a[76:79], v[132:135]
  ds_read_b128 a[224:227], v224 offset:16384
  v_cvt_pk_bf16_f32 v188, v196, v197
  v_mfma_f32_16x16x32_bf16 v[136:139], a[128:131], a[80:83], v[164:167]
  v_exp_f32 v198, v154
  v_mfma_f32_16x16x32_bf16 v[136:139], a[132:135], a[84:87], v[136:139]
  ds_read_b128 a[228:231], v225 offset:16384
  v_or3_b32 v221, v221, v187, v188
  v_mfma_f32_16x16x32_bf16 v[136:139], a[136:139], a[88:91], v[136:139]
  v_exp_f32 v199, v155
  v_mfma_f32_16x16x32_bf16 v[136:139], a[140:143], a[92:95], v[136:139]
  ds_read_b128 a[232:235], v226 offset:16384
  v_cvt_pk_bf16_f32 v189, v198, v199
  v_mfma_f32_16x16x32_bf16 v[140:143], a[144:147], a[80:83], v[164:167]
  s_add_u32 m0, s53, 0
  v_exp_f32 v196, v156
  v_mfma_f32_16x16x32_bf16 v[140:143], a[148:151], a[84:87], v[140:143]
  buffer_load_dwordx4 v236, s[20:23], s51 offen offset:0 nt lds
  v_mfma_f32_16x16x32_bf16 v[140:143], a[152:155], a[88:91], v[140:143]
  v_exp_f32 v197, v157
  v_mfma_f32_16x16x32_bf16 v[140:143], a[156:159], a[92:95], v[140:143]
  ds_read_b128 a[236:239], v227 offset:16384
  v_cvt_pk_bf16_f32 v190, v196, v197
  v_mfma_f32_16x16x32_bf16 v[64:67], a[192:195], v[176:179], v[64:67]
  v_exp_f32 v198, v158
  v_mfma_f32_16x16x32_bf16 v[68:71], a[196:199], v[176:179], v[68:71]
  ds_read_b128 a[240:243], v224 offset:20480
  v_or3_b32 v221, v221, v189, v190
  v_mfma_f32_16x16x32_bf16 v[72:75], a[200:203], v[176:179], v[72:75]
  v_exp_f32 v199, v159
  v_mfma_f32_16x16x32_bf16 v[76:79], a[204:207], v[176:179], v[76:79]
  ds_read_b128 a[244:247], v225 offset:20480
  v_cvt_pk_bf16_f32 v191, v198, v199
  v_mfma_f32_16x16x32_bf16 v[80:83], a[208:211], v[176:179], v[80:83]
  buffer_load_dwordx4 v237, s[20:23], s51 offen offset:1024 nt lds
  v_mfma_f32_16x16x32_bf16 v[84:87], a[212:215], v[176:179], v[84:87]
  ds_read_b128 a[248:251], v226 offset:20480
  v_bitop3_b32 v221, v221, v191, s55 bitop3:0xa8
  v_mfma_f32_16x16x32_bf16 v[88:91], a[216:219], v[176:179], v[88:91]
  v_exp_f32 v192, v128
  v_mfma_f32_16x16x32_bf16 v[92:95], a[220:223], v[176:179], v[92:95]
  ds_read_b128 a[252:255], v227 offset:20480
  v_cmp_ne_u32 vcc, 0, v221
  v_mfma_f32_16x16x32_bf16 v[200:203], v[244:247], v[176:179], v[200:203]
  v_exp_f32 v193, v129
  v_mfma_f32_16x16x32_bf16 v[96:99], a[192:195], v[180:183], v[96:99]
  s_cbranch_vccnz L_stub7
L_back7:
  v_cvt_pk_bf16_f32 v176, v192, v193
  v_mfma_f32_16x16x32_bf16 v[100:103], a[196:199], v[180:183], v[100:103]
  v_exp_f32 v194, v130
  v_mfma_f32_16x16x32_bf16 v[104:107], a[200:203], v[180:183], v[104:107]
  buffer_load_dwordx4 v238, s[20:23], s51 offen offset:2048 nt lds
  v_mfma_f32_16x16x32_bf16 v[108:111], a[204:207], v[180:183], v[108:111]
  v_exp_f32 v195, v131
  v_mfma_f32_16x16x32_bf16 v[112:115], a[208:211], v[180:183], v[112:115]
  ds_read_b64_tr_b16 a[160:161], v228 offset:0
  v_cvt_pk_bf16_f32 v177, v194, v195
  v_mfma_f32_16x16x32_bf16 v[116:119], a[212:215], v[180:183], v[116:119]
  v_exp_f32 v192, v132
  v_mfma_f32_16x16x32_bf16 v[120:123], a[216:219], v[180:183], v[120:123]
  buffer_load_dwordx4 v239, s[20:23], s51 offen offset:3072 nt lds
  v_mfma_f32_16x16x32_bf16 v[124:127], a[220:223], v[180:183], v[124:127]
  s_add_u32 s51, s51, 16384
  v_exp_f32 v193, v133
  v_mfma_f32_16x16x32_bf16 v[204:207], v[244:247], v[180:183], v[204:207]
  ds_read_b64_tr_b16 a[162:163], v228 offset:4096
  v_cvt_pk_bf16_f32 v178, v192, v193
  v_mfma_f32_16x16x32_bf16 v[144:147], a[128:131], a[96:99], v[168:171]
  v_exp_f32 v194, v134
  v_mfma_f32_16x16x32_bf16 v[144:147], a[132:135], a[100:103], v[144:147]
  ds_read_b64_tr_b16 a[164:165], v229 offset:0
  v_or3_b32 v220, v176, v177, v178
  v_mfma_f32_16x16x32_bf16 v[144:147], a[136:139], a[104:107], v[144:147]
  v_exp_f32 v195, v135
  v_mfma_f32_16x16x32_bf16 v[144:147], a[140:143], a[108:111], v[144:147]
  ds_read_b64_tr_b16 a[166:167], v229 offset:4096
  v_cvt_pk_bf16_f32 v179, v194, v195
  v_mfma_f32_16x16x32_bf16 v[148:151], a[144:147], a[96:99], v[168:171]
  s_add_u32 m0, s53, 114688
  v_exp_f32 v192, v136
  v_mfma_f32_16x16x32_bf16 v[148:151], a[148:151], a[100:103], v[148:151]
  buffer_load_dwordx4 v240, s[24:27], s52 offen offset:0 nt lds
  v_mfma_f32_16x16x32_bf16 v[148:151], a[152:155], a[104:107], v[148:151]
  v_exp_f32 v193, v137
  v_mfma_f32_16x16x32_bf16 v[148:151], a[156:159], a[108:111], v[148:151]
  ds_read_b64_tr_b16 a[168:169], v230 offset:0
  v_cvt_pk_bf16_f32 v180, v192, v193
  v_mfma_f32_16x16x32_bf16 v[152:155], a[128:131], a[112:115], v[172:175]
  v_exp_f32 v194, v138
  v_mfma_f32_16x16x32_bf16 v[152:155], a[132:135], a[116:119], v[152:155]
  ds_read_b64_tr_b16 a[170:171], v230 offset:4096
  v_or3_b32 v220, v220, v179, v180
  v_mfma_f32_16x16x32_bf16 v[152:155], a[136:139], a[120:123], v[152:155]
  v_exp_f32 v195, v139
  v_mfma_f32_16x16x32_bf16 v[152:155], a[140:143], a[124:127], v[152:155]
  ds_read_b64_tr_b16 a[172:173], v231 offset:0
  v_cvt_pk_bf16_f32 v181, v194, v195
  v_mfma_f32_16x16x32_bf16 v[156:159], a[144:147], a[112:115], v[172:175]
  v_exp_f32 v192, v140
  v_mfma_f32_16x16x32_bf16 v[156:159], a[148:151], a[116:119], v[156:159]
  buffer_load_dwordx4 v241, s[24:27], s52 offen offset:1024 nt lds
  v_mfma_f32_16x16x32_bf16 v[156:159], a[152:155], a[120:123], v[156:159]
  v_exp_f32 v193, v141
  v_mfma_f32_16x16x32_bf16 v[156:159], a[156:159], a[124:127], v[156:159]
  ds_read_b64_tr_b16 a[174:175], v231 offset:4096
  v_cvt_pk_bf16_f32 v182, v192, v193
  v_mfma_f32_16x16x32_bf16 a[0:3], a[192:195], v[184:187], a[0:3]
  v_exp_f32 v194, v142
  v_mfma_f32_16x16x32_bf16 a[4:7], a[196:199], v[184:187], a[4:7]
  ds_read_b64_tr_b16 a[176:177], v232 offset:0
  v_or3_b32 v220, v220, v181, v182
  v_mfma_f32_16x16x32_bf16 a[8:11], a[200:203], v[184:187], a[8:11]
  v_exp_f32 v195, v143
  v_mfma_f32_16x16x32_bf16 a[12:15], a[204:207], v[184:187], a[12:15]
  ds_read_b64_tr_b16 a[178:179], v232 offset:4096
  v_cvt_pk_bf16_f32 v183, v194, v195
  v_mfma_f32_16x16x32_bf16 a[16:19], a[208:211], v[184:187], a[16:19]
  buffer_load_dwordx4 v240, s[24:27], s52 offen offset:2048 nt lds
  v_mfma_f32_16x16x32_bf16 a[20:23], a[212:215], v[184:187], a[20:23]
  ds_read_b64_tr_b16 a[180:181], v233 offset:0
  v_bitop3_b32 v220, v220, v183, s55 bitop3:0xa8
  v_mfma_f32_16x16x32_bf16 a[24:27], a[216:219], v[184:187], a[24:27]
  v_exp_f32 v196, v144
  v_mfma_f32_16x16x32_bf16 a[28:31], a[220:223], v[184:187], a[28:31]
  ds_read_b64_tr_b16 a[182:183], v233 offset:4096
  v_cmp_ne_u32 vcc, 0, v220
  v_mfma_f32_16x16x32_bf16 v[208:211], v[244:247], v[184:187], v[208:211]
  v_exp_f32 v197, v145
  v_mfma_f32_16x16x32_bf16 a[32:35], a[192:195], v[188:191], a[32:35]
  s_cbranch_vccnz L_stub8
L_back8:
  ds_read_b64_tr_b16 a[184:185], v234 offset:0
  v_cvt_pk_bf16_f32 v184, v196, v197
  v_mfma_f32_16x16x32_bf16 a[36:39], a[196:199], v[188:191], a[36:39]
  v_exp_f32 v198, v146
  v_mfma_f32_16x16x32_bf16 a[40:43], a[200:203], v[188:191], a[40:43]
  ds_read_b64_tr_b16 a[186:187], v234 offset:4096
  ds_read_b64_tr_b16 a[188:189], v235 offset:0
  v_mfma_f32_16x16x32_bf16 a[44:47], a[204:207], v[188:191], a[44:47]
  v_exp_f32 v199, v147
  v_mfma_f32_16x16x32_bf16 a[48:51], a[208:211], v[188:191], a[48:51]
  ds_read_b64_tr_b16 a[190:191], v235 offset:4096
  v_cvt_pk_bf16_f32 v185, v198, v199
  v_mfma_f32_16x16x32_bf16 a[52:55], a[212:215], v[188:191], a[52:55]
  v_exp_f32 v196, v148
  v_mfma_f32_16x16x32_bf16 a[56:59], a[216:219], v[188:191], a[56:59]
  buffer_load_dwordx4 v241, s[24:27], s52 offen offset:3072 nt lds
  v_mfma_f32_16x16x32_bf16 a[60:63], a[220:223], v[188:191], a[60:63]
  s_add_u32 s52, s52, 16384
  v_exp_f32 v197, v149
  v_mfma_f32_16x16x32_bf16 v[212:215], v[244:247], v[188:191], v[212:215]
  v_cvt_pk_bf16_f32 v186, v196, v197
  s_waitcnt lgkmcnt(15)
  v_mfma_f32_16x16x32_bf16 v[128:131], a[224:227], a[64:67], v[160:163]
  v_exp_f32 v198, v150
  v_mfma_f32_16x16x32_bf16 v[128:131], a[228:231], a[68:71], v[128:131]
  v_or3_b32 v221, v184, v185, v186
  v_mfma_f32_16x16x32_bf16 v[128:131], a[232:235], a[72:75], v[128:131]
  v_exp_f32 v199, v151
  v_mfma_f32_16x16x32_bf16 v[128:131], a[236:239], a[76:79], v[128:131]
  v_cvt_pk_bf16_f32 v187, v198, v199
  v_mfma_f32_16x16x32_bf16 v[132:135], a[240:243], a[64:67], v[160:163]
  v_exp_f32 v196, v152
  v_mfma_f32_16x16x32_bf16 v[132:135], a[244:247], a[68:71], v[132:135]
  s_waitcnt vmcnt(16) lgkmcnt(0)
  s_barrier
  v_mfma_f32_16x16x32_bf16 v[132:135], a[248:251], a[72:75], v[132:135]
  v_exp_f32 v197, v153
  v_mfma_f32_16x16x32_bf16 v[132:135], a[252:255], a[76:79], v[132:135]
  ds_read_b128 a[128:131], v224 offset:32768
  v_cvt_pk_bf16_f32 v188, v196, v197
  v_mfma_f32_16x16x32_bf16 v[136:139], a[224:227], a[80:83], v[164:167]
  v_exp_f32 v198, v154
  v_mfma_f32_16x16x32_bf16 v[136:139], a[228:231], a[84:87], v[136:139]
  ds_read_b128 a[132:135], v225 offset:32768
  v_or3_b32 v221, v221, v187, v188
  v_mfma_f32_16x16x32_bf16 v[136:139], a[232:235], a[88:91], v[136:139]
  v_exp_f32 v199, v155
  v_mfma_f32_16x16x32_bf16 v[136:139], a[236:239], a[92:95], v[136:139]
  ds_read_b128 a[136:139], v226 offset:32768
  v_cvt_pk_bf16_f32 v189, v198, v199
  v_mfma_f32_16x16x32_bf16 v[140:143], a[240:243], a[80:83], v[164:167]
  s_add_u32 m0, s53, 16384
  v_exp_f32 v196, v156
  v_mfma_f32_16x16x32_bf16 v[140:143], a[244:247], a[84:87], v[140:143]
  buffer_load_dwordx4 v236, s[20:23], s51 offen offset:0 nt lds
  v_mfma_f32_16x16x32_bf16 v[140:143], a[248:251], a[88:91], v[140:143]
  v_exp_f32 v197, v157
  v_mfma_f32_16x16x32_bf16 v[140:143], a[252:255], a[92:95], v[140:143]
  ds_read_b128 a[140:143], v227 offset:32768
  v_cvt_pk_bf16_f32 v190, v196, v197
  v_mfma_f32_16x16x32_bf16 v[64:67], a[160:163], v[176:179], v[64:67]
  v_exp_f32 v198, v158
  v_mfma_f32_16x16x32_bf16 v[68:71], a[164:167], v[176:179], v[68:71]
  ds_read_b128 a[144:147], v224 offset:36864
  v_or3_b32 v221, v221, v189, v190
  v_mfma_f32_16x16x32_bf16 v[72:75], a[168:171], v[176:179], v[72:75]
  v_exp_f32 v199, v159
  v_mfma_f32_16x16x32_bf16 v[76:79], a[172:175], v[176:179], v[76:79]
  ds_read_b128 a[148:151], v225 offset:36864
  v_cvt_pk_bf16_f32 v191, v198, v199
  v_mfma_f32_16x16x32_bf16 v[80:83], a[176:179], v[176:179], v[80:83]
  buffer_load_dwordx4 v237, s[20:23], s51 offen offset:1024 nt lds
  v_mfma_f32_16x16x32_bf16 v[84:87], a[180:183], v[176:179], v[84:87]
  ds_read_b128 a[152:155], v226 offset:36864
  v_bitop3_b32 v221, v221, v191, s55 bitop3:0xa8
  v_mfma_f32_16x16x32_bf16 v[88:91], a[184:187], v[176:179], v[88:91]
  v_exp_f32 v192, v128
  v_mfma_f32_16x16x32_bf16 v[92:95], a[188:191], v[176:179], v[92:95]
  ds_read_b128 a[156:159], v227 offset:36864
  v_cmp_ne_u32 vcc, 0, v221
  v_mfma_f32_16x16x32_bf16 v[200:203], v[244:247], v[176:179], v[200:203]
  v_exp_f32 v193, v129
  v_mfma_f32_16x16x32_bf16 v[96:99], a[160:163], v[180:183], v[96:99]
  s_cbranch_vccnz L_stub9
L_back9:
  v_cvt_pk_bf16_f32 v176, v192, v193
  v_mfma_f32_16x16x32_bf16 v[100:103], a[164:167], v[180:183], v[100:103]
  v_exp_f32 v194, v130
  v_mfma_f32_16x16x32_bf16 v[104:107], a[168:171], v[180:183], v[104:107]
  buffer_load_dwordx4 v238, s[20:23], s51 offen offset:2048 nt lds
  v_mfma_f32_16x16x32_bf16 v[108:111], a[172:175], v[180:183], v[108:111]
  v_exp_f32 v195, v131
  v_mfma_f32_16x16x32_bf16 v[112:115], a[176:179], v[180:183], v[112:115]
  ds_read_b64_tr_b16 a[192:193], v228 offset:16384
  v_cvt_pk_bf16_f32 v177, v194, v195
  v_mfma_f32_16x16x32_bf16 v[116:119], a[180:183], v[180:183], v[116:119]
  v_exp_f32 v192, v132
  v_mfma_f32_16x16x32_bf16 v[120:123], a[184:187], v[180:183], v[120:123]
  buffer_load_dwordx4 v239, s[20:23], s51 offen offset:3072 nt lds
  v_mfma_f32_16x16x32_bf16 v[124:127], a[188:191], v[180:183], v[124:127]
  s_add_u32 s51, s51, 16384
  v_exp_f32 v193, v133
  v_mfma_f32_16x16x32_bf16 v[204:207], v[244:247], v[180:183], v[204:207]
  ds_read_b64_tr_b16 a[194:195], v228 offset:20480
  v_cvt_pk_bf16_f32 v178, v192, v193
  v_mfma_f32_16x16x32_bf16 v[144:147], a[224:227], a[96:99], v[168:171]
  v_exp_f32 v194, v134
  v_mfma_f32_16x16x32_bf16 v[144:147], a[228:231], a[100:103], v[144:147]
  ds_read_b64_tr_b16 a[196:197], v229 offset:16384
  v_or3_b32 v220, v176, v177, v178
  v_mfma_f32_16x16x32_bf16 v[144:147], a[232:235], a[104:107], v[144:147]
  v_exp_f32 v195, v135
  v_mfma_f32_16x16x32_bf16 v[144:147], a[236:239], a[108:111], v[144:147]
  ds_read_b64_tr_b16 a[198:199], v229 offset:20480
  v_cvt_pk_bf16_f32 v179, v194, v195
  v_mfma_f32_16x16x32_bf16 v[148:151], a[240:243], a[96:99], v[168:171]
  s_add_u32 m0, s53, 65536
  v_exp_f32 v192, v136
  v_mfma_f32_16x16x32_bf16 v[148:151], a[244:247], a[100:103], v[148:151]
  buffer_load_dwordx4 v240, s[24:27], s52 offen offset:0 nt lds
  v_mfma_f32_16x16x32_bf16 v[148:151], a[248:251], a[104:107], v[148:151]
  v_exp_f32 v193, v137
  v_mfma_f32_16x16x32_bf16 v[148:151], a[252:255], a[108:111], v[148:151]
  ds_read_b64_tr_b16 a[200:201], v230 offset:16384
  v_cvt_pk_bf16_f32 v180, v192, v193
  v_mfma_f32_16x16x32_bf16 v[152:155], a[224:227], a[112:115], v[172:175]
  v_exp_f32 v194, v138
  v_mfma_f32_16x16x32_bf16 v[152:155], a[228:231], a[116:119], v[152:155]
  ds_read_b64_tr_b16 a[202:203], v230 offset:20480
  v_or3_b32 v220, v220, v179, v180
  v_mfma_f32_16x16x32_bf16 v[152:155], a[232:235], a[120:123], v[152:155]
  v_exp_f32 v195, v139
  v_mfma_f32_16x16x32_bf16 v[152:155], a[236:239], a[124:127], v[152:155]
  ds_read_b64_tr_b16 a[204:205], v231 offset:16384
  v_cvt_pk_bf16_f32 v181, v194, v195
  v_mfma_f32_16x16x32_bf16 v[156:159], a[240:243], a[112:115], v[172:175]
  v_exp_f32 v192, v140
  v_mfma_f32_16x16x32_bf16 v[156:159], a[244:247], a[116:119], v[156:159]
  buffer_load_dwordx4 v241, s[24:27], s52 offen offset:1024 nt lds
  v_mfma_f32_16x16x32_bf16 v[156:159], a[248:251], a[120:123], v[156:159]
  v_exp_f32 v193, v141
  v_mfma_f32_16x16x32_bf16 v[156:159], a[252:255], a[124:127], v[156:159]
  ds_read_b64_tr_b16 a[206:207], v231 offset:20480
  v_cvt_pk_bf16_f32 v182, v192, v193
  v_mfma_f32_16x16x32_bf16 a[0:3], a[160:163], v[184:187], a[0:3]
  v_exp_f32 v194, v142
  v_mfma_f32_16x16x32_bf16 a[4:7], a[164:167], v[184:187], a[4:7]
  ds_read_b64_tr_b16 a[208:209], v232 offset:16384
  v_or3_b32 v220, v220, v181, v182
  v_mfma_f32_16x16x32_bf16 a[8:11], a[168:171], v[184:187], a[8:11]
  v_exp_f32 v195, v143
  v_mfma_f32_16x16x32_bf16 a[12:15], a[172:175], v[184:187], a[12:15]
  ds_read_b64_tr_b16 a[210:211], v232 offset:20480
  v_cvt_pk_bf16_f32 v183, v194, v195
  v_mfma_f32_16x16x32_bf16 a[16:19], a[176:179], v[184:187], a[16:19]
  buffer_load_dwordx4 v240, s[24:27], s52 offen offset:2048 nt lds
  v_mfma_f32_16x16x32_bf16 a[20:23], a[180:183], v[184:187], a[20:23]
  ds_read_b64_tr_b16 a[212:213], v233 offset:16384
  v_bitop3_b32 v220, v220, v183, s55 bitop3:0xa8
  v_mfma_f32_16x16x32_bf16 a[24:27], a[184:187], v[184:187], a[24:27]
  v_exp_f32 v196, v144
  v_mfma_f32_16x16x32_bf16 a[28:31], a[188:191], v[184:187], a[28:31]
  ds_read_b64_tr_b16 a[214:215], v233 offset:20480
  v_cmp_ne_u32 vcc, 0, v220
  v_mfma_f32_16x16x32_bf16 v[208:211], v[244:247], v[184:187], v[208:211]
  v_exp_f32 v197, v145
  v_mfma_f32_16x16x32_bf16 a[32:35], a[160:163], v[188:191], a[32:35]
  s_cbranch_vccnz L_stub10
L_back10:
  ds_read_b64_tr_b16 a[216:217], v234 offset:16384
  v_cvt_pk_bf16_f32 v184, v196, v197
  v_mfma_f32_16x16x32_bf16 a[36:39], a[164:167], v[188:191], a[36:39]
  v_exp_f32 v198, v146
  v_mfma_f32_16x16x32_bf16 a[40:43], a[168:171], v[188:191], a[40:43]
  ds_read_b64_tr_b16 a[218:219], v234 offset:20480
  ds_read_b64_tr_b16 a[220:221], v235 offset:16384
  v_mfma_f32_16x16x32_bf16 a[44:47], a[172:175], v[188:191], a[44:47]
  v_exp_f32 v199, v147
  v_mfma_f32_16x16x32_bf16 a[48:51], a[176:179], v[188:191], a[48:51]
  ds_read_b64_tr_b16 a[222:223], v235 offset:20480
  v_cvt_pk_bf16_f32 v185, v198, v199
  v_mfma_f32_16x16x32_bf16 a[52:55], a[180:183], v[188:191], a[52:55]
  v_exp_f32 v196, v148
  v_mfma_f32_16x16x32_bf16 a[56:59], a[184:187], v[188:191], a[56:59]
  buffer_load_dwordx4 v241, s[24:27], s52 offen offset:3072 nt lds
  v_mfma_f32_16x16x32_bf16 a[60:63], a[188:191], v[188:191], a[60:63]
  s_add_u32 s52, s52, 16384
  v_exp_f32 v197, v149
  v_mfma_f32_16x16x32_bf16 v[212:215], v[244:247], v[188:191], v[212:215]
  v_cvt_pk_bf16_f32 v186, v196, v197
  s_waitcnt lgkmcnt(15)
  v_mfma_f32_16x16x32_bf16 v[128:131], a[128:131], a[64:67], v[160:163]
  v_exp_f32 v198, v150
  v_mfma_f32_16x16x32_bf16 v[128:131], a[132:135], a[68:71], v[128:131]
  v_or3_b32 v221, v184, v185, v186
  v_mfma_f32_16x16x32_bf16 v[128:131], a[136:139], a[72:75], v[128:131]
  v_exp_f32 v199, v151
  v_mfma_f32_16x16x32_bf16 v[128:131], a[140:143], a[76:79], v[128:131]
  v_cvt_pk_bf16_f32 v187, v198, v199
  v_mfma_f32_16x16x32_bf16 v[132:135], a[144:147], a[64:67], v[160:163]
  v_exp_f32 v196, v152
  v_mfma_f32_16x16x32_bf16 v[132:135], a[148:151], a[68:71], v[132:135]
  s_waitcnt vmcnt(16) lgkmcnt(0)
  s_barrier
  v_mfma_f32_16x16x32_bf16 v[132:135], a[152:155], a[72:75], v[132:135]
  v_exp_f32 v197, v153
  v_mfma_f32_16x16x32_bf16 v[132:135], a[156:159], a[76:79], v[132:135]
  ds_read_b128 a[224:227], v224 offset:49152
  v_cvt_pk_bf16_f32 v188, v196, v197
  v_mfma_f32_16x16x32_bf16 v[136:139], a[128:131], a[80:83], v[164:167]
  v_exp_f32 v198, v154
  v_mfma_f32_16x16x32_bf16 v[136:139], a[132:135], a[84:87], v[136:139]
  ds_read_b128 a[228:231], v225 offset:49152
  v_or3_b32 v221, v221, v187, v188
  v_mfma_f32_16x16x32_bf16 v[136:139], a[136:139], a[88:91], v[136:139]
  v_exp_f32 v199, v155
  v_mfma_f32_16x16x32_bf16 v[136:139], a[140:143], a[92:95], v[136:139]
  ds_read_b128 a[232:235], v226 offset:49152
  v_cvt_pk_bf16_f32 v189, v198, v199
  v_mfma_f32_16x16x32_bf16 v[140:143], a[144:147], a[80:83], v[164:167]
  s_add_u32 m0, s53, 32768
  v_exp_f32 v196, v156
  v_mfma_f32_16x16x32_bf16 v[140:143], a[148:151], a[84:87], v[140:143]
  buffer_load_dwordx4 v236, s[20:23], s51 offen offset:0 nt lds
  v_mfma_f32_16x16x32_bf16 v[140:143], a[152:155], a[88:91], v[140:143]
  v_exp_f32 v197, v157
  v_mfma_f32_16x16x32_bf16 v[140:143], a[156:159], a[92:95], v[140:143]
  ds_read_b128 a[236:239], v227 offset:49152
  v_cvt_pk_bf16_f32 v190, v196, v197
  v_mfma_f32_16x16x32_bf16 v[64:67], a[192:195], v[176:179], v[64:67]
  v_exp_f32 v198, v158
  v_mfma_f32_16x16x32_bf16 v[68:71], a[196:199], v[176:179], v[68:71]
  ds_read_b128 a[240:243], v224 offset:53248
  v_or3_b32 v221, v221, v189, v190
  v_mfma_f32_16x16x32_bf16 v[72:75], a[200:203], v[176:179], v[72:75]
  v_exp_f32 v199, v159
  v_mfma_f32_16x16x32_bf16 v[76:79], a[204:207], v[176:179], v[76:79]
  ds_read_b128 a[244:247], v225 offset:53248
  v_cvt_pk_bf16_f32 v191, v198, v199
  v_mfma_f32_16x16x32_bf16 v[80:83], a[208:211], v[176:179], v[80:83]
  buffer_load_dwordx4 v237, s[20:23], s51 offen offset:1024 nt lds
  v_mfma_f32_16x16x32_bf16 v[84:87], a[212:215], v[176:179], v[84:87]
  ds_read_b128 a[248:251], v226 offset:53248
  v_bitop3_b32 v221, v221, v191, s55 bitop3:0xa8
  v_mfma_f32_16x16x32_bf16 v[88:91], a[216:219], v[176:179], v[88:91]
  v_exp_f32 v192, v128
  v_mfma_f32_16x16x32_bf16 v[92:95], a[220:223], v[176:179], v[92:95]
  ds_read_b128 a[252:255], v227 offset:53248
  v_cmp_ne_u32 vcc, 0, v221
  v_mfma_f32_16x16x32_bf16 v[200:203], v[244:247], v[176:179], v[200:203]
  v_exp_f32 v193, v129
  v_mfma_f32_16x16x32_bf16 v[96:99], a[192:195], v[180:183], v[96:99]
  s_cbranch_vccnz L_stub11
L_back11:
  v_cvt_pk_bf16_f32 v176, v192, v193
  v_mfma_f32_16x16x32_bf16 v[100:103], a[196:199], v[180:183], v[100:103]
  v_exp_f32 v194, v130
  v_mfma_f32_16x16x32_bf16 v[104:107], a[200:203], v[180:183], v[104:107]
  buffer_load_dwordx4 v238, s[20:23], s51 offen offset:2048 nt lds
  v_mfma_f32_16x16x32_bf16 v[108:111], a[204:207], v[180:183], v[108:111]
  v_exp_f32 v195, v131
  v_mfma_f32_16x16x32_bf16 v[112:115], a[208:211], v[180:183], v[112:115]
  ds_read_b64_tr_b16 a[160:161], v228 offset:32768
  v_cvt_pk_bf16_f32 v177, v194, v195
  v_mfma_f32_16x16x32_bf16 v[116:119], a[212:215], v[180:183], v[116:119]
  v_exp_f32 v192, v132
  v_mfma_f32_16x16x32_bf16 v[120:123], a[216:219], v[180:183], v[120:123]
  buffer_load_dwordx4 v239, s[20:23], s51 offen offset:3072 nt lds
  v_mfma_f32_16x16x32_bf16 v[124:127], a[220:223], v[180:183], v[124:127]
  s_add_u32 s51, s51, 16384
  v_exp_f32 v193, v133
  v_mfma_f32_16x16x32_bf16 v[204:207], v[244:247], v[180:183], v[204:207]
  ds_read_b64_tr_b16 a[162:163], v228 offset:36864
  v_cvt_pk_bf16_f32 v178, v192, v193
  v_mfma_f32_16x16x32_bf16 v[144:147], a[128:131], a[96:99], v[168:171]
  v_exp_f32 v194, v134
  v_mfma_f32_16x16x32_bf16 v[144:147], a[132:135], a[100:103], v[144:147]
  ds_read_b64_tr_b16 a[164:165], v229 offset:32768
  v_or3_b32 v220, v176, v177, v178
  v_mfma_f32_16x16x32_bf16 v[144:147], a[136:139], a[104:107], v[144:147]
  v_exp_f32 v195, v135
  v_mfma_f32_16x16x32_bf16 v[144:147], a[140:143], a[108:111], v[144:147]
  ds_read_b64_tr_b16 a[166:167], v229 offset:36864
  v_cvt_pk_bf16_f32 v179, v194, v195
  v_mfma_f32_16x16x32_bf16 v[148:151], a[144:147], a[96:99], v[168:171]
  s_add_u32 m0, s53, 81920
  v_exp_f32 v192, v136
  v_mfma_f32_16x16x32_bf16 v[148:151], a[148:151], a[100:103], v[148:151]
  buffer_load_dwordx4 v240, s[24:27], s52 offen offset:0 nt lds
  v_mfma_f32_16x16x32_bf16 v[148:151], a[152:155], a[104:107], v[148:151]
  v_exp_f32 v193, v137
  v_mfma_f32_16x16x32_bf16 v[148:151], a[156:159], a[108:111], v[148:151]
  ds_read_b64_tr_b16 a[168:169], v230 offset:32768
  v_cvt_pk_bf16_f32 v180, v192, v193
  v_mfma_f32_16x16x32_bf16 v[152:155], a[128:131], a[112:115], v[172:175]
  v_exp_f32 v194, v138
  v_mfma_f32_16x16x32_bf16 v[152:155], a[132:135], a[116:119], v[152:155]
  ds_read_b64_tr_b16 a[170:171], v230 offset:36864
  v_or3_b32 v220, v220, v179, v180
  v_mfma_f32_16x16x32_bf16 v[152:155], a[136:139], a[120:123], v[152:155]
  v_exp_f32 v195, v139
  v_mfma_f32_16x16x32_bf16 v[152:155], a[140:143], a[124:127], v[152:155]
  ds_read_b64_tr_b16 a[172:173], v231 offset:32768
  v_cvt_pk_bf16_f32 v181, v194, v195
  v_mfma_f32_16x16x32_bf16 v[156:159], a[144:147], a[112:115], v[172:175]
  v_exp_f32 v192, v140
  v_mfma_f32_16x16x32_bf16 v[156:159], a[148:151], a[116:119], v[156:159]
  buffer_load_dwordx4 v241, s[24:27], s52 offen offset:1024 nt lds
  v_mfma_f32_16x16x32_bf16 v[156:159], a[152:155], a[120:123], v[156:159]
  v_exp_f32 v193, v141
  v_mfma_f32_16x16x32_bf16 v[156:159], a[156:159], a[124:127], v[156:159]
  ds_read_b64_tr_b16 a[174:175], v231 offset:36864
  v_cvt_pk_bf16_f32 v182, v192, v193
  v_mfma_f32_16x16x32_bf16 a[0:3], a[192:195], v[184:187], a[0:3]
  v_exp_f32 v194, v142
  v_mfma_f32_16x16x32_bf16 a[4:7], a[196:199], v[184:187], a[4:7]
  ds_read_b64_tr_b16 a[176:177], v232 offset:32768
  v_or3_b32 v220, v220, v181, v182
  v_mfma_f32_16x16x32_bf16 a[8:11], a[200:203], v[184:187], a[8:11]
  v_exp_f32 v195, v143
  v_mfma_f32_16x16x32_bf16 a[12:15], a[204:207], v[184:187], a[12:15]
  ds_read_b64_tr_b16 a[178:179], v232 offset:36864
  v_cvt_pk_bf16_f32 v183, v194, v195
  v_mfma_f32_16x16x32_bf16 a[16:19], a[208:211], v[184:187], a[16:19]
  buffer_load_dwordx4 v240, s[24:27], s52 offen offset:2048 nt lds
  v_mfma_f32_16x16x32_bf16 a[20:23], a[212:215], v[184:187], a[20:23]
  ds_read_b64_tr_b16 a[180:181], v233 offset:32768
  v_bitop3_b32 v220, v220, v183, s55 bitop3:0xa8
  v_mfma_f32_16x16x32_bf16 a[24:27], a[216:219], v[184:187], a[24:27]
  v_exp_f32 v196, v144
  v_mfma_f32_16x16x32_bf16 a[28:31], a[220:223], v[184:187], a[28:31]
  ds_read_b64_tr_b16 a[182:183], v233 offset:36864
  v_cmp_ne_u32 vcc, 0, v220
  v_mfma_f32_16x16x32_bf16 v[208:211], v[244:247], v[184:187], v[208:211]
  v_exp_f32 v197, v145
  v_mfma_f32_16x16x32_bf16 a[32:35], a[192:195], v[188:191], a[32:35]
  s_cbranch_vccnz L_stub12
L_back12:
  ds_read_b64_tr_b16 a[184:185], v234 offset:32768
  v_cvt_pk_bf16_f32 v184, v196, v197
  v_mfma_f32_16x16x32_bf16 a[36:39], a[196:199], v[188:191], a[36:39]
  v_exp_f32 v198, v146
  v_mfma_f32_16x16x32_bf16 a[40:43], a[200:203], v[188:191], a[40:43]
  ds_read_b64_tr_b16 a[186:187], v234 offset:36864
  ds_read_b64_tr_b16 a[188:189], v235 offset:32768
  v_mfma_f32_16x16x32_bf16 a[44:47], a[204:207], v[188:191], a[44:47]
  v_exp_f32 v199, v147
  v_mfma_f32_16x16x32_bf16 a[48:51], a[208:211], v[188:191], a[48:51]
  ds_read_b64_tr_b16 a[190:191], v235 offset:36864
  v_cvt_pk_bf16_f32 v185, v198, v199
  v_mfma_f32_16x16x32_bf16 a[52:55], a[212:215], v[188:191], a[52:55]
  v_exp_f32 v196, v148
  v_mfma_f32_16x16x32_bf16 a[56:59], a[216:219], v[188:191], a[56:59]
  buffer_load_dwordx4 v241, s[24:27], s52 offen offset:3072 nt lds
  v_mfma_f32_16x16x32_bf16 a[60:63], a[220:223], v[188:191], a[60:63]
  s_add_u32 s52, s52, 16384
  v_exp_f32 v197, v149
  v_mfma_f32_16x16x32_bf16 v[212:215], v[244:247], v[188:191], v[212:215]
  v_cvt_pk_bf16_f32 v186, v196, v197
  s_waitcnt lgkmcnt(15)
  v_mfma_f32_16x16x32_bf16 v[128:131], a[224:227], a[64:67], v[160:163]
  v_exp_f32 v198, v150
  v_mfma_f32_16x16x32_bf16 v[128:131], a[228:231], a[68:71], v[128:131]
  v_or3_b32 v221, v184, v185, v186
  v_mfma_f32_16x16x32_bf16 v[128:131], a[232:235], a[72:75], v[128:131]
  v_exp_f32 v199, v151
  v_mfma_f32_16x16x32_bf16 v[128:131], a[236:239], a[76:79], v[128:131]
  v_cvt_pk_bf16_f32 v187, v198, v199
  v_mfma_f32_16x16x32_bf16 v[132:135], a[240:243], a[64:67], v[160:163]
  v_exp_f32 v196, v152
  v_mfma_f32_16x16x32_bf16 v[132:135], a[244:247], a[68:71], v[132:135]
  s_waitcnt vmcnt(16) lgkmcnt(0)
  s_barrier
  v_mfma_f32_16x16x32_bf16 v[132:135], a[248:251], a[72:75], v[132:135]
  v_exp_f32 v197, v153
  v_mfma_f32_16x16x32_bf16 v[132:135], a[252:255], a[76:79], v[132:135]
  ds_read_b128 a[128:131], v224 offset:0
  v_cvt_pk_bf16_f32 v188, v196, v197
  v_mfma_f32_16x16x32_bf16 v[136:139], a[224:227], a[80:83], v[164:167]
  v_exp_f32 v198, v154
  v_mfma_f32_16x16x32_bf16 v[136:139], a[228:231], a[84:87], v[136:139]
  ds_read_b128 a[132:135], v225 offset:0
  v_or3_b32 v221, v221, v187, v188
  v_mfma_f32_16x16x32_bf16 v[136:139], a[232:235], a[88:91], v[136:139]
  v_exp_f32 v199, v155
  v_mfma_f32_16x16x32_bf16 v[136:139], a[236:239], a[92:95], v[136:139]
  ds_read_b128 a[136:139], v226 offset:0
  v_cvt_pk_bf16_f32 v189, v198, v199
  v_mfma_f32_16x16x32_bf16 v[140:143], a[240:243], a[80:83], v[164:167]
  s_add_u32 m0, s53, 49152
  v_exp_f32 v196, v156
  v_mfma_f32_16x16x32_bf16 v[140:143], a[244:247], a[84:87], v[140:143]
  buffer_load_dwordx4 v236, s[20:23], s51 offen offset:0 nt lds
  v_mfma_f32_16x16x32_bf16 v[140:143], a[248:251], a[88:91], v[140:143]
  v_exp_f32 v197, v157
  v_mfma_f32_16x16x32_bf16 v[140:143], a[252:255], a[92:95], v[140:143]
  ds_read_b128 a[140:143], v227 offset:0
  v_cvt_pk_bf16_f32 v190, v196, v197
  v_mfma_f32_16x16x32_bf16 v[64:67], a[160:163], v[176:179], v[64:67]
  v_exp_f32 v198, v158
  v_mfma_f32_16x16x32_bf16 v[68:71], a[164:167], v[176:179], v[68:71]
  ds_read_b128 a[144:147], v224 offset:4096
  v_or3_b32 v221, v221, v189, v190
  v_mfma_f32_16x16x32_bf16 v[72:75], a[168:171], v[176:179], v[72:75]
  v_exp_f32 v199, v159
  v_mfma_f32_16x16x32_bf16 v[76:79], a[172:175], v[176:179], v[76:79]
  ds_read_b128 a[148:151], v225 offset:4096
  v_cvt_pk_bf16_f32 v191, v198, v199
  v_mfma_f32_16x16x32_bf16 v[80:83], a[176:179], v[176:179], v[80:83]
  buffer_load_dwordx4 v237, s[20:23], s51 offen offset:1024 nt lds
  v_mfma_f32_16x16x32_bf16 v[84:87], a[180:183], v[176:179], v[84:87]
  ds_read_b128 a[152:155], v226 offset:4096
  v_bitop3_b32 v221, v221, v191, s55 bitop3:0xa8
  v_mfma_f32_16x16x32_bf16 v[88:91], a[184:187], v[176:179], v[88:91]
  v_exp_f32 v192, v128
  v_mfma_f32_16x16x32_bf16 v[92:95], a[188:191], v[176:179], v[92:95]
  ds_read_b128 a[156:159], v227 offset:4096
  v_cmp_ne_u32 vcc, 0, v221
  v_mfma_f32_16x16x32_bf16 v[200:203], v[244:247], v[176:179], v[200:203]
  v_exp_f32 v193, v129
  v_mfma_f32_16x16x32_bf16 v[96:99], a[160:163], v[180:183], v[96:99]
  s_cbranch_vccnz L_stub13
L_back13:
  v_cvt_pk_bf16_f32 v176, v192, v193
  v_mfma_f32_16x16x32_bf16 v[100:103], a[164:167], v[180:183], v[100:103]
  v_exp_f32 v194, v130
  v_mfma_f32_16x16x32_bf16 v[104:107], a[168:171], v[180:183], v[104:107]
  buffer_load_dwordx4 v238, s[20:23], s51 offen offset:2048 nt lds
  v_mfma_f32_16x16x32_bf16 v[108:111], a[172:175], v[180:183], v[108:111]
  v_exp_f32 v195, v131
  v_mfma_f32_16x16x32_bf16 v[112:115], a[176:179], v[180:183], v[112:115]
  ds_read_b64_tr_b16 a[192:193], v228 offset:49152
  v_cvt_pk_bf16_f32 v177, v194, v195
  v_mfma_f32_16x16x32_bf16 v[116:119], a[180:183], v[180:183], v[116:119]
  v_exp_f32 v192, v132
  v_mfma_f32_16x16x32_bf16 v[120:123], a[184:187], v[180:183], v[120:123]
  buffer_load_dwordx4 v239, s[20:23], s51 offen offset:3072 nt lds
  v_mfma_f32_16x16x32_bf16 v[124:127], a[188:191], v[180:183], v[124:127]
  s_add_u32 s51, s51, 16384
  v_exp_f32 v193, v133
  v_mfma_f32_16x16x32_bf16 v[204:207], v[244:247], v[180:183], v[204:207]
  ds_read_b64_tr_b16 a[194:195], v228 offset:53248
  v_cvt_pk_bf16_f32 v178, v192, v193
  v_mfma_f32_16x16x32_bf16 v[144:147], a[224:227], a[96:99], v[168:171]
  v_exp_f32 v194, v134
  v_mfma_f32_16x16x32_bf16 v[144:147], a[228:231], a[100:103], v[144:147]
  ds_read_b64_tr_b16 a[196:197], v229 offset:49152
  v_or3_b32 v220, v176, v177, v178
  v_mfma_f32_16x16x32_bf16 v[144:147], a[232:235], a[104:107], v[144:147]
  v_exp_f32 v195, v135
  v_mfma_f32_16x16x32_bf16 v[144:147], a[236:239], a[108:111], v[144:147]
  ds_read_b64_tr_b16 a[198:199], v229 offset:53248
  v_cvt_pk_bf16_f32 v179, v194, v195
  v_mfma_f32_16x16x32_bf16 v[148:151], a[240:243], a[96:99], v[168:171]
  s_add_u32 m0, s53, 98304
  v_exp_f32 v192, v136
  v_mfma_f32_16x16x32_bf16 v[148:151], a[244:247], a[100:103], v[148:151]
  buffer_load_dwordx4 v240, s[24:27], s52 offen offset:0 nt lds
  v_mfma_f32_16x16x32_bf16 v[148:151], a[248:251], a[104:107], v[148:151]
  v_exp_f32 v193, v137
  v_mfma_f32_16x16x32_bf16 v[148:151], a[252:255], a[108:111], v[148:151]
  ds_read_b64_tr_b16 a[200:201], v230 offset:49152
  v_cvt_pk_bf16_f32 v180, v192, v193
  v_mfma_f32_16x16x32_bf16 v[152:155], a[224:227], a[112:115], v[172:175]
  v_exp_f32 v194, v138
  v_mfma_f32_16x16x32_bf16 v[152:155], a[228:231], a[116:119], v[152:155]
  ds_read_b64_tr_b16 a[202:203], v230 offset:53248
  v_or3_b32 v220, v220, v179, v180
  v_mfma_f32_16x16x32_bf16 v[152:155], a[232:235], a[120:123], v[152:155]
  v_exp_f32 v195, v139
  v_mfma_f32_16x16x32_bf16 v[152:155], a[236:239], a[124:127], v[152:155]
  ds_read_b64_tr_b16 a[204:205], v231 offset:49152
  v_cvt_pk_bf16_f32 v181, v194, v195
  v_mfma_f32_16x16x32_bf16 v[156:159], a[240:243], a[112:115], v[172:175]
  v_exp_f32 v192, v140
  v_mfma_f32_16x16x32_bf16 v[156:159], a[244:247], a[116:119], v[156:159]
  buffer_load_dwordx4 v241, s[24:27], s52 offen offset:1024 nt lds
  v_mfma_f32_16x16x32_bf16 v[156:159], a[248:251], a[120:123], v[156:159]
  v_exp_f32 v193, v141
  v_mfma_f32_16x16x32_bf16 v[156:159], a[252:255], a[124:127], v[156:159]
  ds_read_b64_tr_b16 a[206:207], v231 offset:53248
  v_cvt_pk_bf16_f32 v182, v192, v193
  v_mfma_f32_16x16x32_bf16 a[0:3], a[160:163], v[184:187], a[0:3]
  v_exp_f32 v194, v142
  v_mfma_f32_16x16x32_bf16 a[4:7], a[164:167], v[184:187], a[4:7]
  ds_read_b64_tr_b16 a[208:209], v232 offset:49152
  v_or3_b32 v220, v220, v181, v182
  v_mfma_f32_16x16x32_bf16 a[8:11], a[168:171], v[184:187], a[8:11]
  v_exp_f32 v195, v143
  v_mfma_f32_16x16x32_bf16 a[12:15], a[172:175], v[184:187], a[12:15]
  ds_read_b64_tr_b16 a[210:211], v232 offset:53248
  v_cvt_pk_bf16_f32 v183, v194, v195
  v_mfma_f32_16x16x32_bf16 a[16:19], a[176:179], v[184:187], a[16:19]
  buffer_load_dwordx4 v240, s[24:27], s52 offen offset:2048 nt lds
  v_mfma_f32_16x16x32_bf16 a[20:23], a[180:183], v[184:187], a[20:23]
  ds_read_b64_tr_b16 a[212:213], v233 offset:49152
  v_bitop3_b32 v220, v220, v183, s55 bitop3:0xa8
  v_mfma_f32_16x16x32_bf16 a[24:27], a[184:187], v[184:187], a[24:27]
  v_exp_f32 v196, v144
  v_mfma_f32_16x16x32_bf16 a[28:31], a[188:191], v[184:187], a[28:31]
  ds_read_b64_tr_b16 a[214:215], v233 offset:53248
  v_cmp_ne_u32 vcc, 0, v220
  v_mfma_f32_16x16x32_bf16 v[208:211], v[244:247], v[184:187], v[208:211]
  v_exp_f32 v197, v145
  v_mfma_f32_16x16x32_bf16 a[32:35], a[160:163], v[188:191], a[32:35]
  s_cbranch_vccnz L_stub14
L_back14:
  ds_read_b64_tr_b16 a[216:217], v234 offset:49152
  v_cvt_pk_bf16_f32 v184, v196, v197
  v_mfma_f32_16x16x32_bf16 a[36:39], a[164:167], v[188:191], a[36:39]
  v_exp_f32 v198, v146
  v_mfma_f32_16x16x32_bf16 a[40:43], a[168:171], v[188:191], a[40:43]
  ds_read_b64_tr_b16 a[218:219], v234 offset:53248
  ds_read_b64_tr_b16 a[220:221], v235 offset:49152
  v_mfma_f32_16x16x32_bf16 a[44:47], a[172:175], v[188:191], a[44:47]
  v_exp_f32 v199, v147
  v_mfma_f32_16x16x32_bf16 a[48:51], a[176:179], v[188:191], a[48:51]
  ds_read_b64_tr_b16 a[222:223], v235 offset:53248
  v_cvt_pk_bf16_f32 v185, v198, v199
  v_mfma_f32_16x16x32_bf16 a[52:55], a[180:183], v[188:191], a[52:55]
  v_exp_f32 v196, v148
  v_mfma_f32_16x16x32_bf16 a[56:59], a[184:187], v[188:191], a[56:59]
  s_sub_u32 s54, s54, 1
  buffer_load_dwordx4 v241, s[24:27], s52 offen offset:3072 nt lds
  v_mfma_f32_16x16x32_bf16 a[60:63], a[188:191], v[188:191], a[60:63]
  s_add_u32 s52, s52, 16384
  v_exp_f32 v197, v149
  v_mfma_f32_16x16x32_bf16 v[212:215], v[244:247], v[188:191], v[212:215]
  s_cmp_lg_u32 s54, 0
  v_cvt_pk_bf16_f32 v186, v196, v197
  s_cbranch_scc1 L_loop
  s_waitcnt lgkmcnt(15)
  v_mfma_f32_16x16x32_bf16 v[128:131], a[128:131], a[64:67], v[160:163]
  v_exp_f32 v198, v150
  v_mfma_f32_16x16x32_bf16 v[128:131], a[132:135], a[68:71], v[128:131]
  v_or3_b32 v221, v184, v185, v186
  v_mfma_f32_16x16x32_bf16 v[128:131], a[136:139], a[72:75], v[128:131]
  v_exp_f32 v199, v151
  v_mfma_f32_16x16x32_bf16 v[128:131], a[140:143], a[76:79], v[128:131]
  v_cvt_pk_bf16_f32 v187, v198, v199
  v_mfma_f32_16x16x32_bf16 v[132:135], a[144:147], a[64:67], v[160:163]
  v_exp_f32 v196, v152
  v_mfma_f32_16x16x32_bf16 v[132:135], a[148:151], a[68:71], v[132:135]
  s_waitcnt vmcnt(16) lgkmcnt(0)
  s_barrier
  v_mfma_f32_16x16x32_bf16 v[132:135], a[152:155], a[72:75], v[132:135]
  v_exp_f32 v197, v153
  v_mfma_f32_16x16x32_bf16 v[132:135], a[156:159], a[76:79], v[132:135]
  ds_read_b128 a[224:227], v224 offset:16384
  v_cvt_pk_bf16_f32 v188, v196, v197
  v_mfma_f32_16x16x32_bf16 v[136:139], a[128:131], a[80:83], v[164:167]
  v_exp_f32 v198, v154
  v_mfma_f32_16x16x32_bf16 v[136:139], a[132:135], a[84:87], v[136:139]
  ds_read_b128 a[228:231], v225 offset:16384
  v_or3_b32 v221, v221, v187, v188
  v_mfma_f32_16x16x32_bf16 v[136:139], a[136:139], a[88:91], v[136:139]
  v_exp_f32 v199, v155
  v_mfma_f32_16x16x32_bf16 v[136:139], a[140:143], a[92:95], v[136:139]
  ds_read_b128 a[232:235], v226 offset:16384
  v_cvt_pk_bf16_f32 v189, v198, v199
  v_mfma_f32_16x16x32_bf16 v[140:143], a[144:147], a[80:83], v[164:167]
  s_add_u32 m0, s53, 0
  v_exp_f32 v196, v156
  v_mfma_f32_16x16x32_bf16 v[140:143], a[148:151], a[84:87], v[140:143]
  buffer_load_dwordx4 v236, s[20:23], s51 offen offset:0 nt lds
  v_mfma_f32_16x16x32_bf16 v[140:143], a[152:155], a[88:91], v[140:143]
  v_exp_f32 v197, v157
  v_mfma_f32_16x16x32_bf16 v[140:143], a[156:159], a[92:95], v[140:143]
  ds_read_b128 a[236:239], v227 offset:16384
  v_cvt_pk_bf16_f32 v190, v196, v197
  v_mfma_f32_16x16x32_bf16 v[64:67], a[192:195], v[176:179], v[64:67]
  v_exp_f32 v198, v158
  v_mfma_f32_16x16x32_bf16 v[68:71], a[196:199], v[176:179], v[68:71]
  ds_read_b128 a[240:243], v224 offset:20480
  v_or3_b32 v221, v221, v189, v190
  v_mfma_f32_16x16x32_bf16 v[72:75], a[200:203], v[176:179], v[72:75]
  v_exp_f32 v199, v159
  v_mfma_f32_16x16x32_bf16 v[76:79], a[204:207], v[176:179], v[76:79]
  ds_read_b128 a[244:247], v225 offset:20480
  v_cvt_pk_bf16_f32 v191, v198, v199
  v_mfma_f32_16x16x32_bf16 v[80:83], a[208:211], v[176:179], v[80:83]
  buffer_load_dwordx4 v237, s[20:23], s51 offen offset:1024 nt lds
  v_mfma_f32_16x16x32_bf16 v[84:87], a[212:215], v[176:179], v[84:87]
  ds_read_b128 a[248:251], v226 offset:20480
  v_bitop3_b32 v221, v221, v191, s55 bitop3:0xa8
  v_mfma_f32_16x16x32_bf16 v[88:91], a[216:219], v[176:179], v[88:91]
  v_exp_f32 v192, v128
  v_mfma_f32_16x16x32_bf16 v[92:95], a[220:223], v[176:179], v[92:95]
  ds_read_b128 a[252:255], v227 offset:20480
  v_cmp_ne_u32 vcc, 0, v221
  v_mfma_f32_16x16x32_bf16 v[200:203], v[244:247], v[176:179], v[200:203]
  v_exp_f32 v193, v129
  v_mfma_f32_16x16x32_bf16 v[96:99], a[192:195], v[180:183], v[96:99]
  s_cbranch_vccnz L_stub15
L_back15:
  v_cvt_pk_bf16_f32 v176, v192, v193
  v_mfma_f32_16x16x32_bf16 v[100:103], a[196:199], v[180:183], v[100:103]
  v_exp_f32 v194, v130
  v_mfma_f32_16x16x32_bf16 v[104:107], a[200:203], v[180:183], v[104:107]
  buffer_load_dwordx4 v238, s[20:23], s51 offen offset:2048 nt lds
  v_mfma_f32_16x16x32_bf16 v[108:111], a[204:207], v[180:183], v[108:111]
  v_exp_f32 v195, v131
  v_mfma_f32_16x16x32_bf16 v[112:115], a[208:211], v[180:183], v[112:115]
  ds_read_b64_tr_b16 a[160:161], v228 offset:0
  v_cvt_pk_bf16_f32 v177, v194, v195
  v_mfma_f32_16x16x32_bf16 v[116:119], a[212:215], v[180:183], v[116:119]
  v_exp_f32 v192, v132
  v_mfma_f32_16x16x32_bf16 v[120:123], a[216:219], v[180:183], v[120:123]
  buffer_load_dwordx4 v239, s[20:23], s51 offen offset:3072 nt lds
  v_mfma_f32_16x16x32_bf16 v[124:127], a[220:223], v[180:183], v[124:127]
  s_add_u32 s51, s51, 16384
  v_exp_f32 v193, v133
  v_mfma_f32_16x16x32_bf16 v[204:207], v[244:247], v[180:183], v[204:207]
  ds_read_b64_tr_b16 a[162:163], v228 offset:4096
  v_cvt_pk_bf16_f32 v178, v192, v193
  v_mfma_f32_16x16x32_bf16 v[144:147], a[128:131], a[96:99], v[168:171]
  v_exp_f32 v194, v134
  v_mfma_f32_16x16x32_bf16 v[144:147], a[132:135], a[100:103], v[144:147]
  ds_read_b64_tr_b16 a[164:165], v229 offset:0
  v_or3_b32 v220, v176, v177, v178
  v_mfma_f32_16x16x32_bf16 v[144:147], a[136:139], a[104:107], v[144:147]
  v_exp_f32 v195, v135
  v_mfma_f32_16x16x32_bf16 v[144:147], a[140:143], a[108:111], v[144:147]
  ds_read_b64_tr_b16 a[166:167], v229 offset:4096
  v_cvt_pk_bf16_f32 v179, v194, v195
  v_mfma_f32_16x16x32_bf16 v[148:151], a[144:147], a[96:99], v[168:171]
  s_add_u32 m0, s53, 114688
  v_exp_f32 v192, v136
  v_mfma_f32_16x16x32_bf16 v[148:151], a[148:151], a[100:103], v[148:151]
  buffer_load_dwordx4 v240, s[24:27], s52 offen offset:0 nt lds
  v_mfma_f32_16x16x32_bf16 v[148:151], a[152:155], a[104:107], v[148:151]
  v_exp_f32 v193, v137
  v_mfma_f32_16x16x32_bf16 v[148:151], a[156:159], a[108:111], v[148:151]
  ds_read_b64_tr_b16 a[168:169], v230 offset:0
  v_cvt_pk_bf16_f32 v180, v192, v193
  v_mfma_f32_16x16x32_bf16 v[152:155], a[128:131], a[112:115], v[172:175]
  v_exp_f32 v194, v138
  v_mfma_f32_16x16x32_bf16 v[152:155], a[132:135], a[116:119], v[152:155]
  ds_read_b64_tr_b16 a[170:171], v230 offset:4096
  v_or3_b32 v220, v220, v179, v180
  v_mfma_f32_16x16x32_bf16 v[152:155], a[136:139], a[120:123], v[152:155]
  v_exp_f32 v195, v139
  v_mfma_f32_16x16x32_bf16 v[152:155], a[140:143], a[124:127], v[152:155]
  ds_read_b64_tr_b16 a[172:173], v231 offset:0
  v_cvt_pk_bf16_f32 v181, v194, v195
  v_mfma_f32_16x16x32_bf16 v[156:159], a[144:147], a[112:115], v[172:175]
  v_exp_f32 v192, v140
  v_mfma_f32_16x16x32_bf16 v[156:159], a[148:151], a[116:119], v[156:159]
  buffer_load_dwordx4 v241, s[24:27], s52 offen offset:1024 nt lds
  v_mfma_f32_16x16x32_bf16 v[156:159], a[152:155], a[120:123], v[156:159]
  v_exp_f32 v193, v141
  v_mfma_f32_16x16x32_bf16 v[156:159], a[156:159], a[124:127], v[156:159]
  ds_read_b64_tr_b16 a[174:175], v231 offset:4096
  v_cvt_pk_bf16_f32 v182, v192, v193
  v_mfma_f32_16x16x32_bf16 a[0:3], a[192:195], v[184:187], a[0:3]
  v_exp_f32 v194, v142
  v_mfma_f32_16x16x32_bf16 a[4:7], a[196:199], v[184:187], a[4:7]
  ds_read_b64_tr_b16 a[176:177], v232 offset:0
  v_or3_b32 v220, v220, v181, v182
  v_mfma_f32_16x16x32_bf16 a[8:11], a[200:203], v[184:187], a[8:11]
  v_exp_f32 v195, v143
  v_mfma_f32_16x16x32_bf16 a[12:15], a[204:207], v[184:187], a[12:15]
  ds_read_b64_tr_b16 a[178:179], v232 offset:4096
  v_cvt_pk_bf16_f32 v183, v194, v195
  v_mfma_f32_16x16x32_bf16 a[16:19], a[208:211], v[184:187], a[16:19]
  buffer_load_dwordx4 v240, s[24:27], s52 offen offset:2048 nt lds
  v_mfma_f32_16x16x32_bf16 a[20:23], a[212:215], v[184:187], a[20:23]
  ds_read_b64_tr_b16 a[180:181], v233 offset:0
  v_bitop3_b32 v220, v220, v183, s55 bitop3:0xa8
  v_mfma_f32_16x16x32_bf16 a[24:27], a[216:219], v[184:187], a[24:27]
  v_exp_f32 v196, v144
  v_mfma_f32_16x16x32_bf16 a[28:31], a[220:223], v[184:187], a[28:31]
  ds_read_b64_tr_b16 a[182:183], v233 offset:4096
  v_cmp_ne_u32 vcc, 0, v220
  v_mfma_f32_16x16x32_bf16 v[208:211], v[244:247], v[184:187], v[208:211]
  v_exp_f32 v197, v145
  v_mfma_f32_16x16x32_bf16 a[32:35], a[192:195], v[188:191], a[32:35]
  s_cbranch_vccnz L_stub16
L_back16:
  ds_read_b64_tr_b16 a[184:185], v234 offset:0
  v_cvt_pk_bf16_f32 v184, v196, v197
  v_mfma_f32_16x16x32_bf16 a[36:39], a[196:199], v[188:191], a[36:39]
  v_exp_f32 v198, v146
  v_mfma_f32_16x16x32_bf16 a[40:43], a[200:203], v[188:191], a[40:43]
  ds_read_b64_tr_b16 a[186:187], v234 offset:4096
  ds_read_b64_tr_b16 a[188:189], v235 offset:0
  v_mfma_f32_16x16x32_bf16 a[44:47], a[204:207], v[188:191], a[44:47]
  v_exp_f32 v199, v147
  v_mfma_f32_16x16x32_bf16 a[48:51], a[208:211], v[188:191], a[48:51]
  ds_read_b64_tr_b16 a[190:191], v235 offset:4096
  v_cvt_pk_bf16_f32 v185, v198, v199
  v_mfma_f32_16x16x32_bf16 a[52:55], a[212:215], v[188:191], a[52:55]
  v_exp_f32 v196, v148
  v_mfma_f32_16x16x32_bf16 a[56:59], a[216:219], v[188:191], a[56:59]
  buffer_load_dwordx4 v241, s[24:27], s52 offen offset:3072 nt lds
  v_mfma_f32_16x16x32_bf16 a[60:63], a[220:223], v[188:191], a[60:63]
  s_add_u32 s52, s52, 16384
  v_exp_f32 v197, v149
  v_mfma_f32_16x16x32_bf16 v[212:215], v[244:247], v[188:191], v[212:215]
  v_cvt_pk_bf16_f32 v186, v196, v197
  s_waitcnt lgkmcnt(15)
  v_mfma_f32_16x16x32_bf16 v[128:131], a[224:227], a[64:67], v[160:163]
  v_exp_f32 v198, v150
  v_mfma_f32_16x16x32_bf16 v[128:131], a[228:231], a[68:71], v[128:131]
  v_or3_b32 v221, v184, v185, v186
  v_mfma_f32_16x16x32_bf16 v[128:131], a[232:235], a[72:75], v[128:131]
  v_exp_f32 v199, v151
  v_mfma_f32_16x16x32_bf16 v[128:131], a[236:239], a[76:79], v[128:131]
  v_cvt_pk_bf16_f32 v187, v198, v199
  v_mfma_f32_16x16x32_bf16 v[132:135], a[240:243], a[64:67], v[160:163]
  v_exp_f32 v196, v152
  v_mfma_f32_16x16x32_bf16 v[132:135], a[244:247], a[68:71], v[132:135]
  s_waitcnt vmcnt(16) lgkmcnt(0)
  s_barrier
  v_mfma_f32_16x16x32_bf16 v[132:135], a[248:251], a[72:75], v[132:135]
  v_exp_f32 v197, v153
  v_mfma_f32_16x16x32_bf16 v[132:135], a[252:255], a[76:79], v[132:135]
  ds_read_b128 a[128:131], v224 offset:32768
  v_cvt_pk_bf16_f32 v188, v196, v197
  v_mfma_f32_16x16x32_bf16 v[136:139], a[224:227], a[80:83], v[164:167]
  v_exp_f32 v198, v154
  v_mfma_f32_16x16x32_bf16 v[136:139], a[228:231], a[84:87], v[136:139]
  ds_read_b128 a[132:135], v225 offset:32768
  v_or3_b32 v221, v221, v187, v188
  v_mfma_f32_16x16x32_bf16 v[136:139], a[232:235], a[88:91], v[136:139]
  v_exp_f32 v199, v155
  v_mfma_f32_16x16x32_bf16 v[136:139], a[236:239], a[92:95], v[136:139]
  ds_read_b128 a[136:139], v226 offset:32768
  v_cvt_pk_bf16_f32 v189, v198, v199
  v_mfma_f32_16x16x32_bf16 v[140:143], a[240:243], a[80:83], v[164:167]
  v_exp_f32 v196, v156
  v_mfma_f32_16x16x32_bf16 v[140:143], a[244:247], a[84:87], v[140:143]
  v_mfma_f32_16x16x32_bf16 v[140:143], a[248:251], a[88:91], v[140:143]
  v_exp_f32 v197, v157
  v_mfma_f32_16x16x32_bf16 v[140:143], a[252:255], a[92:95], v[140:143]
  ds_read_b128 a[140:143], v227 offset:32768
  v_cvt_pk_bf16_f32 v190, v196, v197
  v_mfma_f32_16x16x32_bf16 v[64:67], a[160:163], v[176:179], v[64:67]
  v_exp_f32 v198, v158
  v_mfma_f32_16x16x32_bf16 v[68:71], a[164:167], v[176:179], v[68:71]
  ds_read_b128 a[144:147], v224 offset:36864
  v_or3_b32 v221, v221, v189, v190
  v_mfma_f32_16x16x32_bf16 v[72:75], a[168:171], v[176:179], v[72:75]
  v_exp_f32 v199, v159
  v_mfma_f32_16x16x32_bf16 v[76:79], a[172:175], v[176:179], v[76:79]
  ds_read_b128 a[148:151], v225 offset:36864
  v_cvt_pk_bf16_f32 v191, v198, v199
  v_mfma_f32_16x16x32_bf16 v[80:83], a[176:179], v[176:179], v[80:83]
  v_mfma_f32_16x16x32_bf16 v[84:87], a[180:183], v[176:179], v[84:87]
  ds_read_b128 a[152:155], v226 offset:36864
  v_bitop3_b32 v221, v221, v191, s55 bitop3:0xa8
  v_mfma_f32_16x16x32_bf16 v[88:91], a[184:187], v[176:179], v[88:91]
  v_exp_f32 v192, v128
  v_mfma_f32_16x16x32_bf16 v[92:95], a[188:191], v[176:179], v[92:95]
  ds_read_b128 a[156:159], v227 offset:36864
  v_cmp_ne_u32 vcc, 0, v221
  v_mfma_f32_16x16x32_bf16 v[200:203], v[244:247], v[176:179], v[200:203]
  v_exp_f32 v193, v129
  v_mfma_f32_16x16x32_bf16 v[96:99], a[160:163], v[180:183], v[96:99]
  s_cbranch_vccnz L_stub17
L_back17:
  v_cvt_pk_bf16_f32 v176, v192, v193
  v_mfma_f32_16x16x32_bf16 v[100:103], a[164:167], v[180:183], v[100:103]
  v_exp_f32 v194, v130
  v_mfma_f32_16x16x32_bf16 v[104:107], a[168:171], v[180:183], v[104:107]
  v_mfma_f32_16x16x32_bf16 v[108:111], a[172:175], v[180:183], v[108:111]
  v_exp_f32 v195, v131
  v_mfma_f32_16x16x32_bf16 v[112:115], a[176:179], v[180:183], v[112:115]
  ds_read_b64_tr_b16 a[192:193], v228 offset:16384
  v_cvt_pk_bf16_f32 v177, v194, v195
  v_mfma_f32_16x16x32_bf16 v[116:119], a[180:183], v[180:183], v[116:119]
  v_exp_f32 v192, v132
  v_mfma_f32_16x16x32_bf16 v[120:123], a[184:187], v[180:183], v[120:123]
  v_mfma_f32_16x16x32_bf16 v[124:127], a[188:191], v[180:183], v[124:127]
  v_exp_f32 v193, v133
  v_mfma_f32_16x16x32_bf16 v[204:207], v[244:247], v[180:183], v[204:207]
  ds_read_b64_tr_b16 a[194:195], v228 offset:20480
  v_cvt_pk_bf16_f32 v178, v192, v193
  v_mfma_f32_16x16x32_bf16 v[144:147], a[224:227], a[96:99], v[168:171]
  v_exp_f32 v194, v134
  v_mfma_f32_16x16x32_bf16 v[144:147], a[228:231], a[100:103], v[144:147]
  ds_read_b64_tr_b16 a[196:197], v229 offset:16384
  v_or3_b32 v220, v176, v177, v178
  v_mfma_f32_16x16x32_bf16 v[144:147], a[232:235], a[104:107], v[144:147]
  v_exp_f32 v195, v135
  v_mfma_f32_16x16x32_bf16 v[144:147], a[236:239], a[108:111], v[144:147]
  ds_read_b64_tr_b16 a[198:199], v229 offset:20480
  v_cvt_pk_bf16_f32 v179, v194, v195
  v_mfma_f32_16x16x32_bf16 v[148:151], a[240:243], a[96:99], v[168:171]
  v_exp_f32 v192, v136
  v_mfma_f32_16x16x32_bf16 v[148:151], a[244:247], a[100:103], v[148:151]
  v_mfma_f32_16x16x32_bf16 v[148:151], a[248:251], a[104:107], v[148:151]
  v_exp_f32 v193, v137
  v_mfma_f32_16x16x32_bf16 v[148:151], a[252:255], a[108:111], v[148:151]
  ds_read_b64_tr_b16 a[200:201], v230 offset:16384
  v_cvt_pk_bf16_f32 v180, v192, v193
  v_mfma_f32_16x16x32_bf16 v[152:155], a[224:227], a[112:115], v[172:175]
  v_exp_f32 v194, v138
  v_mfma_f32_16x16x32_bf16 v[152:155], a[228:231], a[116:119], v[152:155]
  ds_read_b64_tr_b16 a[202:203], v230 offset:20480
  v_or3_b32 v220, v220, v179, v180
  v_mfma_f32_16x16x32_bf16 v[152:155], a[232:235], a[120:123], v[152:155]
  v_exp_f32 v195, v139
  v_mfma_f32_16x16x32_bf16 v[152:155], a[236:239], a[124:127], v[152:155]
  ds_read_b64_tr_b16 a[204:205], v231 offset:16384
  v_cvt_pk_bf16_f32 v181, v194, v195
  v_mfma_f32_16x16x32_bf16 v[156:159], a[240:243], a[112:115], v[172:175]
  v_exp_f32 v192, v140
  v_mfma_f32_16x16x32_bf16 v[156:159], a[244:247], a[116:119], v[156:159]
  v_mfma_f32_16x16x32_bf16 v[156:159], a[248:251], a[120:123], v[156:159]
  v_exp_f32 v193, v141
  v_mfma_f32_16x16x32_bf16 v[156:159], a[252:255], a[124:127], v[156:159]
  ds_read_b64_tr_b16 a[206:207], v231 offset:20480
  v_cvt_pk_bf16_f32 v182, v192, v193
  v_mfma_f32_16x16x32_bf16 a[0:3], a[160:163], v[184:187], a[0:3]
  v_exp_f32 v194, v142
  v_mfma_f32_16x16x32_bf16 a[4:7], a[164:167], v[184:187], a[4:7]
  ds_read_b64_tr_b16 a[208:209], v232 offset:16384
  v_or3_b32 v220, v220, v181, v182
  v_mfma_f32_16x16x32_bf16 a[8:11], a[168:171], v[184:187], a[8:11]
  v_exp_f32 v195, v143
  v_mfma_f32_16x16x32_bf16 a[12:15], a[172:175], v[184:187], a[12:15]
  ds_read_b64_tr_b16 a[210:211], v232 offset:20480
  v_cvt_pk_bf16_f32 v183, v194, v195
  v_mfma_f32_16x16x32_bf16 a[16:19], a[176:179], v[184:187], a[16:19]
  v_mfma_f32_16x16x32_bf16 a[20:23], a[180:183], v[184:187], a[20:23]
  ds_read_b64_tr_b16 a[212:213], v233 offset:16384
  v_bitop3_b32 v220, v220, v183, s55 bitop3:0xa8
  v_mfma_f32_16x16x32_bf16 a[24:27], a[184:187], v[184:187], a[24:27]
  v_exp_f32 v196, v144
  v_mfma_f32_16x16x32_bf16 a[28:31], a[188:191], v[184:187], a[28:31]
  ds_read_b64_tr_b16 a[214:215], v233 offset:20480
  v_cmp_ne_u32 vcc, 0, v220
  v_mfma_f32_16x16x32_bf16 v[208:211], v[244:247], v[184:187], v[208:211]
  v_exp_f32 v197, v145
  v_mfma_f32_16x16x32_bf16 a[32:35], a[160:163], v[188:191], a[32:35]
  s_cbranch_vccnz L_stub18
L_back18:
  ds_read_b64_tr_b16 a[216:217], v234 offset:16384
  v_cvt_pk_bf16_f32 v184, v196, v197
  v_mfma_f32_16x16x32_bf16 a[36:39], a[164:167], v[188:191], a[36:39]
  v_exp_f32 v198, v146
  v_mfma_f32_16x16x32_bf16 a[40:43], a[168:171], v[188:191], a[40:43]
  ds_read_b64_tr_b16 a[218:219], v234 offset:20480
  ds_read_b64_tr_b16 a[220:221], v235 offset:16384
  v_mfma_f32_16x16x32_bf16 a[44:47], a[172:175], v[188:191], a[44:47]
  v_exp_f32 v199, v147
  v_mfma_f32_16x16x32_bf16 a[48:51], a[176:179], v[188:191], a[48:51]
  ds_read_b64_tr_b16 a[222:223], v235 offset:20480
  v_cvt_pk_bf16_f32 v185, v198, v199
  v_mfma_f32_16x16x32_bf16 a[52:55], a[180:183], v[188:191], a[52:55]
  v_exp_f32 v196, v148
  v_mfma_f32_16x16x32_bf16 a[56:59], a[184:187], v[188:191], a[56:59]
  v_mfma_f32_16x16x32_bf16 a[60:63], a[188:191], v[188:191], a[60:63]
  v_exp_f32 v197, v149
  v_mfma_f32_16x16x32_bf16 v[212:215], v[244:247], v[188:191], v[212:215]
  v_cvt_pk_bf16_f32 v186, v196, v197
  s_waitcnt lgkmcnt(15)
  v_mfma_f32_16x16x32_bf16 v[128:131], a[128:131], a[64:67], v[160:163]
  v_exp_f32 v198, v150
  v_mfma_f32_16x16x32_bf16 v[128:131], a[132:135], a[68:71], v[128:131]
  v_or3_b32 v221, v184, v185, v186
  v_mfma_f32_16x16x32_bf16 v[128:131], a[136:139], a[72:75], v[128:131]
  v_exp_f32 v199, v151
  v_mfma_f32_16x16x32_bf16 v[128:131], a[140:143], a[76:79], v[128:131]
  v_cvt_pk_bf16_f32 v187, v198, v199
  v_mfma_f32_16x16x32_bf16 v[132:135], a[144:147], a[64:67], v[160:163]
  v_exp_f32 v196, v152
  v_mfma_f32_16x16x32_bf16 v[132:135], a[148:151], a[68:71], v[132:135]
  s_waitcnt vmcnt(8) lgkmcnt(0)
  s_barrier
  v_mfma_f32_16x16x32_bf16 v[132:135], a[152:155], a[72:75], v[132:135]
  v_exp_f32 v197, v153
  v_mfma_f32_16x16x32_bf16 v[132:135], a[156:159], a[76:79], v[132:135]
  ds_read_b128 a[224:227], v224 offset:49152
  v_cvt_pk_bf16_f32 v188, v196, v197
  v_mfma_f32_16x16x32_bf16 v[136:139], a[128:131], a[80:83], v[164:167]
  v_exp_f32 v198, v154
  v_mfma_f32_16x16x32_bf16 v[136:139], a[132:135], a[84:87], v[136:139]
  ds_read_b128 a[228:231], v225 offset:49152
  v_or3_b32 v221, v221, v187, v188
  v_mfma_f32_16x16x32_bf16 v[136:139], a[136:139], a[88:91], v[136:139]
  v_exp_f32 v199, v155
  v_mfma_f32_16x16x32_bf16 v[136:139], a[140:143], a[92:95], v[136:139]
  ds_read_b128 a[232:235], v226 offset:49152
  v_cvt_pk_bf16_f32 v189, v198, v199
  v_mfma_f32_16x16x32_bf16 v[140:143], a[144:147], a[80:83], v[164:167]
  v_exp_f32 v196, v156
  v_mfma_f32_16x16x32_bf16 v[140:143], a[148:151], a[84:87], v[140:143]
  v_mfma_f32_16x16x32_bf16 v[140:143], a[152:155], a[88:91], v[140:143]
  v_exp_f32 v197, v157
  v_mfma_f32_16x16x32_bf16 v[140:143], a[156:159], a[92:95], v[140:143]
  ds_read_b128 a[236:239], v227 offset:49152
  v_cvt_pk_bf16_f32 v190, v196, v197
  v_mfma_f32_16x16x32_bf16 v[64:67], a[192:195], v[176:179], v[64:67]
  v_exp_f32 v198, v158
  v_mfma_f32_16x16x32_bf16 v[68:71], a[196:199], v[176:179], v[68:71]
  ds_read_b128 a[240:243], v224 offset:53248
  v_or3_b32 v221, v221, v189, v190
  v_mfma_f32_16x16x32_bf16 v[72:75], a[200:203], v[176:179], v[72:75]
  v_exp_f32 v199, v159
  v_mfma_f32_16x16x32_bf16 v[76:79], a[204:207], v[176:179], v[76:79]
  ds_read_b128 a[244:247], v225 offset:53248
  v_cvt_pk_bf16_f32 v191, v198, v199
  v_mfma_f32_16x16x32_bf16 v[80:83], a[208:211], v[176:179], v[80:83]
  v_mfma_f32_16x16x32_bf16 v[84:87], a[212:215], v[176:179], v[84:87]
  ds_read_b128 a[248:251], v226 offset:53248
  v_bitop3_b32 v221, v221, v191, s55 bitop3:0xa8
  v_mfma_f32_16x16x32_bf16 v[88:91], a[216:219], v[176:179], v[88:91]
  v_exp_f32 v192, v128
  v_mfma_f32_16x16x32_bf16 v[92:95], a[220:223], v[176:179], v[92:95]
  ds_read_b128 a[252:255], v227 offset:53248
  v_cmp_ne_u32 vcc, 0, v221
  v_mfma_f32_16x16x32_bf16 v[200:203], v[244:247], v[176:179], v[200:203]
  v_exp_f32 v193, v129
  v_mfma_f32_16x16x32_bf16 v[96:99], a[192:195], v[180:183], v[96:99]
  s_cbranch_vccnz L_stub19
L_back19:
  v_cvt_pk_bf16_f32 v176, v192, v193
  v_mfma_f32_16x16x32_bf16 v[100:103], a[196:199], v[180:183], v[100:103]
  v_exp_f32 v194, v130
  v_mfma_f32_16x16x32_bf16 v[104:107], a[200:203], v[180:183], v[104:107]
  v_mfma_f32_16x16x32_bf16 v[108:111], a[204:207], v[180:183], v[108:111]
  v_exp_f32 v195, v131
  v_mfma_f32_16x16x32_bf16 v[112:115], a[208:211], v[180:183], v[112:115]
  ds_read_b64_tr_b16 a[160:161], v228 offset:32768
  v_cvt_pk_bf16_f32 v177, v194, v195
  v_mfma_f32_16x16x32_bf16 v[116:119], a[212:215], v[180:183], v[116:119]
  v_exp_f32 v192, v132
  v_mfma_f32_16x16x32_bf16 v[120:123], a[216:219], v[180:183], v[120:123]
  v_mfma_f32_16x16x32_bf16 v[124:127], a[220:223], v[180:183], v[124:127]
  v_exp_f32 v193, v133
  v_mfma_f32_16x16x32_bf16 v[204:207], v[244:247], v[180:183], v[204:207]
  ds_read_b64_tr_b16 a[162:163], v228 offset:36864
  v_cvt_pk_bf16_f32 v178, v192, v193
  v_mfma_f32_16x16x32_bf16 v[144:147], a[128:131], a[96:99], v[168:171]
  v_exp_f32 v194, v134
  v_mfma_f32_16x16x32_bf16 v[144:147], a[132:135], a[100:103], v[144:147]
  ds_read_b64_tr_b16 a[164:165], v229 offset:32768
  v_or3_b32 v220, v176, v177, v178
  v_mfma_f32_16x16x32_bf16 v[144:147], a[136:139], a[104:107], v[144:147]
  v_exp_f32 v195, v135
  v_mfma_f32_16x16x32_bf16 v[144:147], a[140:143], a[108:111], v[144:147]
  ds_read_b64_tr_b16 a[166:167], v229 offset:36864
  v_cvt_pk_bf16_f32 v179, v194, v195
  v_mfma_f32_16x16x32_bf16 v[148:151], a[144:147], a[96:99], v[168:171]
  v_exp_f32 v192, v136
  v_mfma_f32_16x16x32_bf16 v[148:151], a[148:151], a[100:103], v[148:151]
  v_mfma_f32_16x16x32_bf16 v[148:151], a[152:155], a[104:107], v[148:151]
  v_exp_f32 v193, v137
  v_mfma_f32_16x16x32_bf16 v[148:151], a[156:159], a[108:111], v[148:151]
  ds_read_b64_tr_b16 a[168:169], v230 offset:32768
  v_cvt_pk_bf16_f32 v180, v192, v193
  v_mfma_f32_16x16x32_bf16 v[152:155], a[128:131], a[112:115], v[172:175]
  v_exp_f32 v194, v138
  v_mfma_f32_16x16x32_bf16 v[152:155], a[132:135], a[116:119], v[152:155]
  ds_read_b64_tr_b16 a[170:171], v230 offset:36864
  v_or3_b32 v220, v220, v179, v180
  v_mfma_f32_16x16x32_bf16 v[152:155], a[136:139], a[120:123], v[152:155]
  v_exp_f32 v195, v139
  v_mfma_f32_16x16x32_bf16 v[152:155], a[140:143], a[124:127], v[152:155]
  ds_read_b64_tr_b16 a[172:173], v231 offset:32768
  v_cvt_pk_bf16_f32 v181, v194, v195
  v_mfma_f32_16x16x32_bf16 v[156:159], a[144:147], a[112:115], v[172:175]
  v_exp_f32 v192, v140
  v_mfma_f32_16x16x32_bf16 v[156:159], a[148:151], a[116:119], v[156:159]
  v_mfma_f32_16x16x32_bf16 v[156:159], a[152:155], a[120:123], v[156:159]
  v_exp_f32 v193, v141
  v_mfma_f32_16x16x32_bf16 v[156:159], a[156:159], a[124:127], v[156:159]
  ds_read_b64_tr_b16 a[174:175], v231 offset:36864
  v_cvt_pk_bf16_f32 v182, v192, v193
  v_mfma_f32_16x16x32_bf16 a[0:3], a[192:195], v[184:187], a[0:3]
  v_exp_f32 v194, v142
  v_mfma_f32_16x16x32_bf16 a[4:7], a[196:199], v[184:187], a[4:7]
  ds_read_b64_tr_b16 a[176:177], v232 offset:32768
  v_or3_b32 v220, v220, v181, v182
  v_mfma_f32_16x16x32_bf16 a[8:11], a[200:203], v[184:187], a[8:11]
  v_exp_f32 v195, v143
  v_mfma_f32_16x16x32_bf16 a[12:15], a[204:207], v[184:187], a[12:15]
  ds_read_b64_tr_b16 a[178:179], v232 offset:36864
  v_cvt_pk_bf16_f32 v183, v194, v195
  v_mfma_f32_16x16x32_bf16 a[16:19], a[208:211], v[184:187], a[16:19]
  v_mfma_f32_16x16x32_bf16 a[20:23], a[212:215], v[184:187], a[20:23]
  ds_read_b64_tr_b16 a[180:181], v233 offset:32768
  v_bitop3_b32 v220, v220, v183, s55 bitop3:0xa8
  v_mfma_f32_16x16x32_bf16 a[24:27], a[216:219], v[184:187], a[24:27]
  v_exp_f32 v196, v144
  v_mfma_f32_16x16x32_bf16 a[28:31], a[220:223], v[184:187], a[28:31]
  ds_read_b64_tr_b16 a[182:183], v233 offset:36864
  v_cmp_ne_u32 vcc, 0, v220
  v_mfma_f32_16x16x32_bf16 v[208:211], v[244:247], v[184:187], v[208:211]
  v_exp_f32 v197, v145
  v_mfma_f32_16x16x32_bf16 a[32:35], a[192:195], v[188:191], a[32:35]
  s_cbranch_vccnz L_stub20
L_back20:
  ds_read_b64_tr_b16 a[184:185], v234 offset:32768
  v_cvt_pk_bf16_f32 v184, v196, v197
  v_mfma_f32_16x16x32_bf16 a[36:39], a[196:199], v[188:191], a[36:39]
  v_exp_f32 v198, v146
  v_mfma_f32_16x16x32_bf16 a[40:43], a[200:203], v[188:191], a[40:43]
  ds_read_b64_tr_b16 a[186:187], v234 offset:36864
  ds_read_b64_tr_b16 a[188:189], v235 offset:32768
  v_mfma_f32_16x16x32_bf16 a[44:47], a[204:207], v[188:191], a[44:47]
  v_exp_f32 v199, v147
  v_mfma_f32_16x16x32_bf16 a[48:51], a[208:211], v[188:191], a[48:51]
  ds_read_b64_tr_b16 a[190:191], v235 offset:36864
  v_cvt_pk_bf16_f32 v185, v198, v199
  v_mfma_f32_16x16x32_bf16 a[52:55], a[212:215], v[188:191], a[52:55]
  v_exp_f32 v196, v148
  v_mfma_f32_16x16x32_bf16 a[56:59], a[216:219], v[188:191], a[56:59]
  v_mfma_f32_16x16x32_bf16 a[60:63], a[220:223], v[188:191], a[60:63]
  v_exp_f32 v197, v149
  v_mfma_f32_16x16x32_bf16 v[212:215], v[244:247], v[188:191], v[212:215]
  v_cvt_pk_bf16_f32 v186, v196, v197
  s_waitcnt lgkmcnt(15)
  v_mfma_f32_16x16x32_bf16 v[128:131], a[224:227], a[64:67], v[160:163]
  v_exp_f32 v198, v150
  v_mfma_f32_16x16x32_bf16 v[128:131], a[228:231], a[68:71], v[128:131]
  v_or3_b32 v221, v184, v185, v186
  v_mfma_f32_16x16x32_bf16 v[128:131], a[232:235], a[72:75], v[128:131]
  v_exp_f32 v199, v151
  v_mfma_f32_16x16x32_bf16 v[128:131], a[236:239], a[76:79], v[128:131]
  v_cvt_pk_bf16_f32 v187, v198, v199
  v_mfma_f32_16x16x32_bf16 v[132:135], a[240:243], a[64:67], v[160:163]
  v_exp_f32 v196, v152
  v_mfma_f32_16x16x32_bf16 v[132:135], a[244:247], a[68:71], v[132:135]
  v_mfma_f32_16x16x32_bf16 v[132:135], a[248:251], a[72:75], v[132:135]
  v_exp_f32 v197, v153
  v_mfma_f32_16x16x32_bf16 v[132:135], a[252:255], a[76:79], v[132:135]
  v_cvt_pk_bf16_f32 v188, v196, v197
  v_mfma_f32_16x16x32_bf16 v[136:139], a[224:227], a[80:83], v[164:167]
  v_exp_f32 v198, v154
  v_mfma_f32_16x16x32_bf16 v[136:139], a[228:231], a[84:87], v[136:139]
  v_or3_b32 v221, v221, v187, v188
  v_mfma_f32_16x16x32_bf16 v[136:139], a[232:235], a[88:91], v[136:139]
  v_exp_f32 v199, v155
  v_mfma_f32_16x16x32_bf16 v[136:139], a[236:239], a[92:95], v[136:139]
  v_cvt_pk_bf16_f32 v189, v198, v199
  v_mfma_f32_16x16x32_bf16 v[140:143], a[240:243], a[80:83], v[164:167]
  v_exp_f32 v196, v156
  v_mfma_f32_16x16x32_bf16 v[140:143], a[244:247], a[84:87], v[140:143]
  v_mfma_f32_16x16x32_bf16 v[140:143], a[248:251], a[88:91], v[140:143]
  v_exp_f32 v197, v157
  v_mfma_f32_16x16x32_bf16 v[140:143], a[252:255], a[92:95], v[140:143]
  v_cvt_pk_bf16_f32 v190, v196, v197
  s_waitcnt lgkmcnt(0)
  v_mfma_f32_16x16x32_bf16 v[64:67], a[160:163], v[176:179], v[64:67]
  v_exp_f32 v198, v158
  v_mfma_f32_16x16x32_bf16 v[68:71], a[164:167], v[176:179], v[68:71]
  v_or3_b32 v221, v221, v189, v190
  v_mfma_f32_16x16x32_bf16 v[72:75], a[168:171], v[176:179], v[72:75]
  v_exp_f32 v199, v159
  v_mfma_f32_16x16x32_bf16 v[76:79], a[172:175], v[176:179], v[76:79]
  v_cvt_pk_bf16_f32 v191, v198, v199
  v_mfma_f32_16x16x32_bf16 v[80:83], a[176:179], v[176:179], v[80:83]
  v_mfma_f32_16x16x32_bf16 v[84:87], a[180:183], v[176:179], v[84:87]
  v_bitop3_b32 v221, v221, v191, s55 bitop3:0xa8
  v_mfma_f32_16x16x32_bf16 v[88:91], a[184:187], v[176:179], v[88:91]
  v_exp_f32 v192, v128
  v_mfma_f32_16x16x32_bf16 v[92:95], a[188:191], v[176:179], v[92:95]
  v_cmp_ne_u32 vcc, 0, v221
  v_mfma_f32_16x16x32_bf16 v[200:203], v[244:247], v[176:179], v[200:203]
  v_exp_f32 v193, v129
  v_mfma_f32_16x16x32_bf16 v[96:99], a[160:163], v[180:183], v[96:99]
  s_cbranch_vccnz L_stub21
L_back21:
  v_cvt_pk_bf16_f32 v176, v192, v193
  v_mfma_f32_16x16x32_bf16 v[100:103], a[164:167], v[180:183], v[100:103]
  v_exp_f32 v194, v130
  v_mfma_f32_16x16x32_bf16 v[104:107], a[168:171], v[180:183], v[104:107]
  s_waitcnt vmcnt(0) lgkmcnt(0)
  s_barrier
  v_mfma_f32_16x16x32_bf16 v[108:111], a[172:175], v[180:183], v[108:111]
  v_exp_f32 v195, v131
  v_mfma_f32_16x16x32_bf16 v[112:115], a[176:179], v[180:183], v[112:115]
  ds_read_b64_tr_b16 a[192:193], v228 offset:49152
  v_cvt_pk_bf16_f32 v177, v194, v195
  v_mfma_f32_16x16x32_bf16 v[116:119], a[180:183], v[180:183], v[116:119]
  v_exp_f32 v192, v132
  v_mfma_f32_16x16x32_bf16 v[120:123], a[184:187], v[180:183], v[120:123]
  v_mfma_f32_16x16x32_bf16 v[124:127], a[188:191], v[180:183], v[124:127]
  v_exp_f32 v193, v133
  v_mfma_f32_16x16x32_bf16 v[204:207], v[244:247], v[180:183], v[204:207]
  ds_read_b64_tr_b16 a[194:195], v228 offset:53248
  v_cvt_pk_bf16_f32 v178, v192, v193
  v_mfma_f32_16x16x32_bf16 v[144:147], a[224:227], a[96:99], v[168:171]
  v_exp_f32 v194, v134
  v_mfma_f32_16x16x32_bf16 v[144:147], a[228:231], a[100:103], v[144:147]
  ds_read_b64_tr_b16 a[196:197], v229 offset:49152
  v_or3_b32 v220, v176, v177, v178
  v_mfma_f32_16x16x32_bf16 v[144:147], a[232:235], a[104:107], v[144:147]
  v_exp_f32 v195, v135
  v_mfma_f32_16x16x32_bf16 v[144:147], a[236:239], a[108:111], v[144:147]
  ds_read_b64_tr_b16 a[198:199], v229 offset:53248
  v_cvt_pk_bf16_f32 v179, v194, v195
  v_mfma_f32_16x16x32_bf16 v[148:151], a[240:243], a[96:99], v[168:171]
  v_exp_f32 v192, v136
  v_mfma_f32_16x16x32_bf16 v[148:151], a[244:247], a[100:103], v[148:151]
  v_mfma_f32_16x16x32_bf16 v[148:151], a[248:251], a[104:107], v[148:151]
  v_exp_f32 v193, v137
  v_mfma_f32_16x16x32_bf16 v[148:151], a[252:255], a[108:111], v[148:151]
  ds_read_b64_tr_b16 a[200:201], v230 offset:49152
  v_cvt_pk_bf16_f32 v180, v192, v193
  v_mfma_f32_16x16x32_bf16 v[152:155], a[224:227], a[112:115], v[172:175]
  v_exp_f32 v194, v138
  v_mfma_f32_16x16x32_bf16 v[152:155], a[228:231], a[116:119], v[152:155]
  ds_read_b64_tr_b16 a[202:203], v230 offset:53248
  v_or3_b32 v220, v220, v179, v180
  v_mfma_f32_16x16x32_bf16 v[152:155], a[232:235], a[120:123], v[152:155]
  v_exp_f32 v195, v139
  v_mfma_f32_16x16x32_bf16 v[152:155], a[236:239], a[124:127], v[152:155]
  ds_read_b64_tr_b16 a[204:205], v231 offset:49152
  v_cvt_pk_bf16_f32 v181, v194, v195
  v_mfma_f32_16x16x32_bf16 v[156:159], a[240:243], a[112:115], v[172:175]
  v_exp_f32 v192, v140
  v_mfma_f32_16x16x32_bf16 v[156:159], a[244:247], a[116:119], v[156:159]
  v_mfma_f32_16x16x32_bf16 v[156:159], a[248:251], a[120:123], v[156:159]
  v_exp_f32 v193, v141
  v_mfma_f32_16x16x32_bf16 v[156:159], a[252:255], a[124:127], v[156:159]
  ds_read_b64_tr_b16 a[206:207], v231 offset:53248
  v_cvt_pk_bf16_f32 v182, v192, v193
  v_mfma_f32_16x16x32_bf16 a[0:3], a[160:163], v[184:187], a[0:3]
  v_exp_f32 v194, v142
  v_mfma_f32_16x16x32_bf16 a[4:7], a[164:167], v[184:187], a[4:7]
  ds_read_b64_tr_b16 a[208:209], v232 offset:49152
  v_or3_b32 v220, v220, v181, v182
  v_mfma_f32_16x16x32_bf16 a[8:11], a[168:171], v[184:187], a[8:11]
  v_exp_f32 v195, v143
  v_mfma_f32_16x16x32_bf16 a[12:15], a[172:175], v[184:187], a[12:15]
  ds_read_b64_tr_b16 a[210:211], v232 offset:53248
  v_cvt_pk_bf16_f32 v183, v194, v195
  v_mfma_f32_16x16x32_bf16 a[16:19], a[176:179], v[184:187], a[16:19]
  v_mfma_f32_16x16x32_bf16 a[20:23], a[180:183], v[184:187], a[20:23]
  ds_read_b64_tr_b16 a[212:213], v233 offset:49152
  v_bitop3_b32 v220, v220, v183, s55 bitop3:0xa8
  v_mfma_f32_16x16x32_bf16 a[24:27], a[184:187], v[184:187], a[24:27]
  v_exp_f32 v196, v144
  v_mfma_f32_16x16x32_bf16 a[28:31], a[188:191], v[184:187], a[28:31]
  ds_read_b64_tr_b16 a[214:215], v233 offset:53248
  v_cmp_ne_u32 vcc, 0, v220
  v_mfma_f32_16x16x32_bf16 v[208:211], v[244:247], v[184:187], v[208:211]
  v_exp_f32 v197, v145
  v_mfma_f32_16x16x32_bf16 a[32:35], a[160:163], v[188:191], a[32:35]
  s_cbranch_vccnz L_stub22
L_back22:
  ds_read_b64_tr_b16 a[216:217], v234 offset:49152
  v_cvt_pk_bf16_f32 v184, v196, v197
  v_mfma_f32_16x16x32_bf16 a[36:39], a[164:167], v[188:191], a[36:39]
  v_exp_f32 v198, v146
  v_mfma_f32_16x16x32_bf16 a[40:43], a[168:171], v[188:191], a[40:43]
  ds_read_b64_tr_b16 a[218:219], v234 offset:53248
  ds_read_b64_tr_b16 a[220:221], v235 offset:49152
  v_mfma_f32_16x16x32_bf16 a[44:47], a[172:175], v[188:191], a[44:47]
  v_exp_f32 v199, v147
  v_mfma_f32_16x16x32_bf16 a[48:51], a[176:179], v[188:191], a[48:51]
  ds_read_b64_tr_b16 a[222:223], v235 offset:53248
  v_cvt_pk_bf16_f32 v185, v198, v199
  v_mfma_f32_16x16x32_bf16 a[52:55], a[180:183], v[188:191], a[52:55]
  v_exp_f32 v196, v148
  v_mfma_f32_16x16x32_bf16 a[56:59], a[184:187], v[188:191], a[56:59]
  v_mfma_f32_16x16x32_bf16 a[60:63], a[188:191], v[188:191], a[60:63]
  v_exp_f32 v197, v149
  v_mfma_f32_16x16x32_bf16 v[212:215], v[244:247], v[188:191], v[212:215]
  v_cvt_pk_bf16_f32 v186, v196, v197
  v_lshlrev_b32 v32, 4, v222
  s_lshl_b32 s62, s48, 14
  s_xor_b32 s63, s62, 16384
  v_add_u32 v33, s62, v32
  v_add_u32 v34, s63, v32
  s_lshl_b32 s62, s48, 10
  s_add_u32 s62, s62, 147456
  s_xor_b32 s63, s62, 1024
  v_add_u32 v35, s62, v32
  v_add_u32 v36, s63, v32
  s_waitcnt lgkmcnt(0)
  v_mfma_f32_16x16x32_bf16 v[64:67], a[192:195], v[176:179], v[64:67]
  v_exp_f32 v198, v150
  v_or3_b32 v221, v184, v185, v186
  v_exp_f32 v199, v151
  v_mfma_f32_16x16x32_bf16 v[68:71], a[196:199], v[176:179], v[68:71]
  s_nop 0
  v_cvt_pk_bf16_f32 v187, v198, v199
  v_exp_f32 v196, v152
  v_mfma_f32_16x16x32_bf16 v[72:75], a[200:203], v[176:179], v[72:75]
  v_exp_f32 v197, v153
  s_nop 0
  v_cvt_pk_bf16_f32 v188, v196, v197
  v_mfma_f32_16x16x32_bf16 v[76:79], a[204:207], v[176:179], v[76:79]
  v_exp_f32 v198, v154
  v_or3_b32 v221, v221, v187, v188
  v_exp_f32 v199, v155
  v_mfma_f32_16x16x32_bf16 v[80:83], a[208:211], v[176:179], v[80:83]
  s_nop 0
  v_cvt_pk_bf16_f32 v189, v198, v199
  v_exp_f32 v196, v156
  v_mfma_f32_16x16x32_bf16 v[84:87], a[212:215], v[176:179], v[84:87]
  v_exp_f32 v197, v157
  s_nop 0
  v_cvt_pk_bf16_f32 v190, v196, v197
  v_mfma_f32_16x16x32_bf16 v[88:91], a[216:219], v[176:179], v[88:91]
  v_exp_f32 v198, v158
  v_or3_b32 v221, v221, v189, v190
  v_exp_f32 v199, v159
  v_mfma_f32_16x16x32_bf16 v[92:95], a[220:223], v[176:179], v[92:95]
  s_nop 0
  v_cvt_pk_bf16_f32 v191, v198, v199
  v_bitop3_b32 v221, v221, v191, s55 bitop3:0xa8
  v_mfma_f32_16x16x32_bf16 v[200:203], v[244:247], v[176:179], v[200:203]
  v_cmp_ne_u32 vcc, 0, v221
  s_cbranch_vccnz L_stub23
L_back23:
  s_nop 1
  v_mfma_f32_16x16x32_bf16 a[0:3], a[192:195], v[184:187], a[0:3]
  s_lshl_b32 s64, s48, 14
  s_add_u32 s64, s64, 65536
  v_and_b32 v42, 15, v222
  v_mfma_f32_16x16x32_bf16 a[4:7], a[196:199], v[184:187], a[4:7]
  v_lshrrev_b32 v43, 4, v222
  v_mul_u32_u24 v40, 272, v42
  v_mfma_f32_16x16x32_bf16 a[8:11], a[200:203], v[184:187], a[8:11]
  v_and_b32 v44, 1, v43
  v_lshl_add_u32 v40, v44, 5, v40
  v_mfma_f32_16x16x32_bf16 a[12:15], a[204:207], v[184:187], a[12:15]
  v_lshrrev_b32 v44, 1, v43
  v_mfma_f32_16x16x32_bf16 a[16:19], a[208:211], v[184:187], a[16:19]
  ds_write_b128 v33, a[0:3] offset:0
  v_mfma_f32_16x16x32_bf16 a[20:23], a[212:215], v[184:187], a[20:23]
  ds_write_b128 v33, a[4:7] offset:1024
  v_mfma_f32_16x16x32_bf16 a[24:27], a[216:219], v[184:187], a[24:27]
  ds_write_b128 v33, a[8:11] offset:2048
  v_mfma_f32_16x16x32_bf16 a[28:31], a[220:223], v[184:187], a[28:31]
  ds_write_b128 v33, a[12:15] offset:3072
  v_mfma_f32_16x16x32_bf16 v[208:211], v[244:247], v[184:187], v[208:211]
  ds_write_b128 v33, a[16:19] offset:4096
  v_mfma_f32_16x16x32_bf16 a[32:35], a[192:195], v[188:191], a[32:35]
  ds_write_b128 v33, a[20:23] offset:5120
  v_mfma_f32_16x16x32_bf16 a[36:39], a[196:199], v[188:191], a[36:39]
  ds_write_b128 v33, a[24:27] offset:6144
  v_mfma_f32_16x16x32_bf16 a[40:43], a[200:203], v[188:191], a[40:43]
  v_mov_b32 v8, v218
  v_mov_b32 v9, v219
  ds_write_b128 v33, a[28:31] offset:7168
  v_mfma_f32_16x16x32_bf16 a[44:47], a[204:207], v[188:191], a[44:47]
  v_mov_b32 v10, v208
  v_mfma_f32_16x16x32_bf16 a[48:51], a[208:211], v[188:191], a[48:51]
  ds_write_b128 v33, a[32:35] offset:8192
  v_mfma_f32_16x16x32_bf16 a[52:55], a[212:215], v[188:191], a[52:55]
  ds_write_b128 v33, a[36:39] offset:9216
  v_mfma_f32_16x16x32_bf16 a[56:59], a[216:219], v[188:191], a[56:59]
  ds_write_b128 v33, a[40:43] offset:10240
  v_mfma_f32_16x16x32_bf16 a[60:63], a[220:223], v[188:191], a[60:63]
  ds_write_b128 v33, a[44:47] offset:11264
  v_mfma_f32_16x16x32_bf16 v[212:215], v[244:247], v[188:191], v[212:215]
  ds_write_b128 v33, a[48:51] offset:12288
  v_mfma_f32_16x16x32_bf16 v[96:99], a[192:195], v[180:183], v[96:99]
  ds_write_b128 v33, a[52:55] offset:13312
  v_mfma_f32_16x16x32_bf16 v[100:103], a[196:199], v[180:183], v[100:103]
  ds_write_b128 v33, a[56:59] offset:14336
  v_mfma_f32_16x16x32_bf16 v[104:107], a[200:203], v[180:183], v[104:107]
  ds_write_b128 v33, a[60:63] offset:15360
  v_mfma_f32_16x16x32_bf16 v[108:111], a[204:207], v[180:183], v[108:111]
  v_mov_b32 v11, v212
  v_mfma_f32_16x16x32_bf16 v[112:115], a[208:211], v[180:183], v[112:115]
  v_lshl_add_u32 v40, v44, 4, v40
  v_add_u32 v40, s64, v40
  ds_write_b128 v35, v[8:11]
  v_mfma_f32_16x16x32_bf16 v[116:119], a[212:215], v[180:183], v[116:119]
  v_mul_u32_u24 v41, 272, v43
  v_lshl_add_u32 v41, v42, 4, v41
  v_mfma_f32_16x16x32_bf16 v[120:123], a[216:219], v[180:183], v[120:123]
  v_add_u32 v41, s64, v41
  v_mfma_f32_16x16x32_bf16 v[124:127], a[220:223], v[180:183], v[124:127]
  v_mfma_f32_16x16x32_bf16 v[204:207], v[244:247], v[180:183], v[204:207]
  s_waitcnt lgkmcnt(0)
  s_barrier
  ds_read_b128 v[8:11], v36
  ds_read_b128 v[128:131], v34 offset:0
  ds_read_b128 v[132:135], v34 offset:1024
  ds_read_b128 v[136:139], v34 offset:2048
  ds_read_b128 v[140:143], v34 offset:3072
  ds_read_b128 v[144:147], v34 offset:4096
  ds_read_b128 v[148:151], v34 offset:5120
  ds_read_b128 v[152:155], v34 offset:6144
  ds_read_b128 v[156:159], v34 offset:7168
  ds_read_b128 v[160:163], v34 offset:8192
  ds_read_b128 v[164:167], v34 offset:9216
  ds_read_b128 v[168:171], v34 offset:10240
  ds_read_b128 v[172:175], v34 offset:11264
  ds_read_b128 v[176:179], v34 offset:12288
  ds_read_b128 v[180:183], v34 offset:13312
  ds_read_b128 v[184:187], v34 offset:14336
  ds_read_b128 v[188:191], v34 offset:15360
  s_waitcnt lgkmcnt(15)
  v_max_f32 v12, v216, v8
  v_max_f32 v13, v217, v9
  v_sub_f32 v24, v216, v12
  v_sub_f32 v26, v8, v12
  v_sub_f32 v25, v217, v13
  v_sub_f32 v27, v9, v13
  v_exp_f32 v24, v24
  v_exp_f32 v26, v26
  v_exp_f32 v25, v25
  v_exp_f32 v27, v27
  s_nop 0
  v_mul_f32 v28, v200, v24
  v_mul_f32 v29, v204, v25
  v_fma_f32 v28, v10, v26, v28
  v_fma_f32 v29, v11, v27, v29
  v_rcp_f32 v28, v28
  v_rcp_f32 v29, v29
  s_nop 0
  v_mul_f32 v16, v24, v28
  v_mul_f32 v18, v26, v28
  v_mul_f32 v20, v25, v29
  v_mul_f32 v22, v27, v29
  v_mov_b32 v17, v16
  v_mov_b32 v19, v18
  v_mov_b32 v21, v20
  v_mov_b32 v23, v22
  s_lshl_b32 s62, s48, 13
  s_add_u32 s63, s62, 4096
  s_waitcnt lgkmcnt(14)
  v_pk_mul_f32 v[128:129], v[128:129], v[18:19]
  v_pk_mul_f32 v[130:131], v[130:131], v[18:19]
  v_pk_mul_f32 v[132:133], v[132:133], v[18:19]
  v_pk_mul_f32 v[134:135], v[134:135], v[18:19]
  v_pk_fma_f32 v[128:129], v[64:65], v[16:17], v[128:129]
  v_pk_fma_f32 v[130:131], v[66:67], v[16:17], v[130:131]
  v_pk_fma_f32 v[132:133], v[68:69], v[16:17], v[132:133]
  v_pk_fma_f32 v[134:135], v[70:71], v[16:17], v[134:135]
  v_cvt_pk_bf16_f32 v48, v128, v129
  v_cvt_pk_bf16_f32 v49, v130, v131
  v_cvt_pk_bf16_f32 v50, v132, v133
  v_cvt_pk_bf16_f32 v51, v134, v135
  s_nop 1
  v_permlane16_swap_b32 v48, v50
  v_permlane16_swap_b32 v49, v51
  s_nop 1
  ds_write_b128 v40, v[48:51] offset:0
  s_waitcnt lgkmcnt(13)
  v_pk_mul_f32 v[136:137], v[136:137], v[18:19]
  v_pk_mul_f32 v[138:139], v[138:139], v[18:19]
  v_pk_mul_f32 v[140:141], v[140:141], v[18:19]
  v_pk_mul_f32 v[142:143], v[142:143], v[18:19]
  v_pk_fma_f32 v[136:137], v[72:73], v[16:17], v[136:137]
  v_pk_fma_f32 v[138:139], v[74:75], v[16:17], v[138:139]
  v_pk_fma_f32 v[140:141], v[76:77], v[16:17], v[140:141]
  v_pk_fma_f32 v[142:143], v[78:79], v[16:17], v[142:143]
  v_cvt_pk_bf16_f32 v52, v136, v137
  v_cvt_pk_bf16_f32 v53, v138, v139
  v_cvt_pk_bf16_f32 v54, v140, v141
  v_cvt_pk_bf16_f32 v55, v142, v143
  s_nop 1
  v_permlane16_swap_b32 v52, v54
  v_permlane16_swap_b32 v53, v55
  s_nop 1
  ds_write_b128 v40, v[52:55] offset:64
  s_waitcnt lgkmcnt(12)
  v_pk_mul_f32 v[144:145], v[144:145], v[18:19]
  v_pk_mul_f32 v[146:147], v[146:147], v[18:19]
  v_pk_mul_f32 v[148:149], v[148:149], v[18:19]
  v_pk_mul_f32 v[150:151], v[150:151], v[18:19]
  v_pk_fma_f32 v[144:145], v[80:81], v[16:17], v[144:145]
  v_pk_fma_f32 v[146:147], v[82:83], v[16:17], v[146:147]
  v_pk_fma_f32 v[148:149], v[84:85], v[16:17], v[148:149]
  v_pk_fma_f32 v[150:151], v[86:87], v[16:17], v[150:151]
  v_cvt_pk_bf16_f32 v56, v144, v145
  v_cvt_pk_bf16_f32 v57, v146, v147
  v_cvt_pk_bf16_f32 v58, v148, v149
  v_cvt_pk_bf16_f32 v59, v150, v151
  s_nop 1
  v_permlane16_swap_b32 v56, v58
  v_permlane16_swap_b32 v57, v59
  s_nop 1
  ds_write_b128 v40, v[56:59] offset:128
  s_waitcnt lgkmcnt(11)
  v_pk_mul_f32 v[152:153], v[152:153], v[18:19]
  v_pk_mul_f32 v[154:155], v[154:155], v[18:19]
  v_pk_mul_f32 v[156:157], v[156:157], v[18:19]
  v_pk_mul_f32 v[158:159], v[158:159], v[18:19]
  v_pk_fma_f32 v[152:153], v[88:89], v[16:17], v[152:153]
  v_pk_fma_f32 v[154:155], v[90:91], v[16:17], v[154:155]
  v_pk_fma_f32 v[156:157], v[92:93], v[16:17], v[156:157]
  v_pk_fma_f32 v[158:159], v[94:95], v[16:17], v[158:159]
  v_cvt_pk_bf16_f32 v60, v152, v153
  v_cvt_pk_bf16_f32 v61, v154, v155
  v_cvt_pk_bf16_f32 v62, v156, v157
  v_cvt_pk_bf16_f32 v63, v158, v159
  s_nop 1
  v_permlane16_swap_b32 v60, v62
  v_permlane16_swap_b32 v61, v63
  s_nop 1
  ds_write_b128 v40, v[60:63] offset:192
  s_waitcnt lgkmcnt(10)
  v_pk_mul_f32 v[160:161], v[160:161], v[22:23]
  v_pk_mul_f32 v[162:163], v[162:163], v[22:23]
  v_pk_mul_f32 v[164:165], v[164:165], v[22:23]
  v_pk_mul_f32 v[166:167], v[166:167], v[22:23]
  v_pk_fma_f32 v[160:161], v[96:97], v[20:21], v[160:161]
  v_pk_fma_f32 v[162:163], v[98:99], v[20:21], v[162:163]
  v_pk_fma_f32 v[164:165], v[100:101], v[20:21], v[164:165]
  v_pk_fma_f32 v[166:167], v[102:103], v[20:21], v[166:167]
  v_cvt_pk_bf16_f32 v48, v160, v161
  v_cvt_pk_bf16_f32 v49, v162, v163
  v_cvt_pk_bf16_f32 v50, v164, v165
  v_cvt_pk_bf16_f32 v51, v166, v167
  s_nop 1
  v_permlane16_swap_b32 v48, v50
  v_permlane16_swap_b32 v49, v51
  s_nop 1
  ds_write_b128 v40, v[48:51] offset:4352
  ds_read_b128 v[64:67], v41 offset:0
  ds_read_b128 v[68:71], v41 offset:1088
  ds_read_b128 v[72:75], v41 offset:2176
  ds_read_b128 v[76:79], v41 offset:3264
  s_waitcnt lgkmcnt(13)
  v_pk_mul_f32 v[168:169], v[168:169], v[22:23]
  v_pk_mul_f32 v[170:171], v[170:171], v[22:23]
  v_pk_mul_f32 v[172:173], v[172:173], v[22:23]
  v_pk_mul_f32 v[174:175], v[174:175], v[22:23]
  v_pk_fma_f32 v[168:169], v[104:105], v[20:21], v[168:169]
  v_pk_fma_f32 v[170:171], v[106:107], v[20:21], v[170:171]
  v_pk_fma_f32 v[172:173], v[108:109], v[20:21], v[172:173]
  v_pk_fma_f32 v[174:175], v[110:111], v[20:21], v[174:175]
  v_cvt_pk_bf16_f32 v52, v168, v169
  v_cvt_pk_bf16_f32 v53, v170, v171
  v_cvt_pk_bf16_f32 v54, v172, v173
  v_cvt_pk_bf16_f32 v55, v174, v175
  s_nop 1
  v_permlane16_swap_b32 v52, v54
  v_permlane16_swap_b32 v53, v55
  s_nop 1
  ds_write_b128 v40, v[52:55] offset:4416
  s_waitcnt lgkmcnt(12)
  v_pk_mul_f32 v[176:177], v[176:177], v[22:23]
  v_pk_mul_f32 v[178:179], v[178:179], v[22:23]
  v_pk_mul_f32 v[180:181], v[180:181], v[22:23]
  v_pk_mul_f32 v[182:183], v[182:183], v[22:23]
  v_pk_fma_f32 v[176:177], v[112:113], v[20:21], v[176:177]
  v_pk_fma_f32 v[178:179], v[114:115], v[20:21], v[178:179]
  v_pk_fma_f32 v[180:181], v[116:117], v[20:21], v[180:181]
  v_pk_fma_f32 v[182:183], v[118:119], v[20:21], v[182:183]
  v_cvt_pk_bf16_f32 v56, v176, v177
  v_cvt_pk_bf16_f32 v57, v178, v179
  v_cvt_pk_bf16_f32 v58, v180, v181
  v_cvt_pk_bf16_f32 v59, v182, v183
  s_waitcnt lgkmcnt(4)
  buffer_store_dwordx4 v[64:67], v32, s[44:47], s62 offen offset:0 nt
  s_waitcnt lgkmcnt(3)
  buffer_store_dwordx4 v[68:71], v32, s[44:47], s62 offen offset:1024 nt
  v_permlane16_swap_b32 v56, v58
  v_permlane16_swap_b32 v57, v59
  s_nop 1
  ds_write_b128 v40, v[56:59] offset:4480
  s_waitcnt lgkmcnt(11)
  v_pk_mul_f32 v[184:185], v[184:185], v[22:23]
  v_pk_mul_f32 v[186:187], v[186:187], v[22:23]
  v_pk_mul_f32 v[188:189], v[188:189], v[22:23]
  v_pk_mul_f32 v[190:191], v[190:191], v[22:23]
  v_pk_fma_f32 v[184:185], v[120:121], v[20:21], v[184:185]
  v_pk_fma_f32 v[186:187], v[122:123], v[20:21], v[186:187]
  v_pk_fma_f32 v[188:189], v[124:125], v[20:21], v[188:189]
  v_pk_fma_f32 v[190:191], v[126:127], v[20:21], v[190:191]
  v_cvt_pk_bf16_f32 v60, v184, v185
  v_cvt_pk_bf16_f32 v61, v186, v187
  v_cvt_pk_bf16_f32 v62, v188, v189
  v_cvt_pk_bf16_f32 v63, v190, v191
  s_waitcnt lgkmcnt(3)
  buffer_store_dwordx4 v[72:75], v32, s[44:47], s62 offen offset:2048 nt
  s_waitcnt lgkmcnt(2)
  buffer_store_dwordx4 v[76:79], v32, s[44:47], s62 offen offset:3072 nt
  v_permlane16_swap_b32 v60, v62
  v_permlane16_swap_b32 v61, v63
  s_nop 1
  ds_write_b128 v40, v[60:63] offset:4544
  ds_read_b128 v[80:83], v41 offset:4352
  ds_read_b128 v[84:87], v41 offset:5440
  ds_read_b128 v[88:91], v41 offset:6528
  ds_read_b128 v[92:95], v41 offset:7616
  s_waitcnt lgkmcnt(3)
  buffer_store_dwordx4 v[80:83], v32, s[44:47], s63 offen offset:0 nt
  s_waitcnt lgkmcnt(2)
  buffer_store_dwordx4 v[84:87], v32, s[44:47], s63 offen offset:1024 nt
  s_waitcnt lgkmcnt(1)
  buffer_store_dwordx4 v[88:91], v32, s[44:47], s63 offen offset:2048 nt
  s_waitcnt lgkmcnt(0)
  buffer_store_dwordx4 v[92:95], v32, s[44:47], s63 offen offset:3072 nt
L_done:
  s_endpgm
L_stub1:
  v_mov_b32 v128, v32
  v_mov_b32 v129, v33
  v_mov_b32 v130, v34
  v_mov_b32 v131, v35
  v_mov_b32 v132, v36
  v_mov_b32 v133, v37
  v_mov_b32 v134, v38
  v_mov_b32 v135, v39
  v_mov_b32 v136, v40
  v_mov_b32 v137, v41
  v_mov_b32 v138, v42
  v_mov_b32 v139, v43
  v_mov_b32 v140, v44
  v_mov_b32 v141, v45
  v_mov_b32 v142, v46
  v_mov_b32 v143, v47
  s_call_b64 s[60:61], L_slowA
  s_branch L_back1
L_stub2:
  s_call_b64 s[60:61], L_slowA
  s_branch L_back2
L_stub3:
  s_call_b64 s[60:61], L_slowB
  s_branch L_back3
L_stub4:
  s_call_b64 s[60:61], L_slowA
  s_branch L_back4
L_stub5:
  s_call_b64 s[60:61], L_slowB
  s_branch L_back5
L_stub6:
  s_call_b64 s[60:61], L_slowA
  s_branch L_back6
L_stub7:
  s_call_b64 s[60:61], L_slowB
  s_branch L_back7
L_stub8:
  s_call_b64 s[60:61], L_slowA
  s_branch L_back8
L_stub9:
  s_call_b64 s[60:61], L_slowB
  s_branch L_back9
L_stub10:
  s_call_b64 s[60:61], L_slowA
  s_branch L_back10
L_stub11:
  s_call_b64 s[60:61], L_slowB
  s_branch L_back11
L_stub12:
  s_call_b64 s[60:61], L_slowA
  s_branch L_back12
L_stub13:
  s_call_b64 s[60:61], L_slowB
  s_branch L_back13
L_stub14:
  s_call_b64 s[60:61], L_slowA
  s_branch L_back14
L_stub15:
  s_call_b64 s[60:61], L_slowB
  s_branch L_back15
L_stub16:
  s_call_b64 s[60:61], L_slowA
  s_branch L_back16
L_stub17:
  s_call_b64 s[60:61], L_slowB
  s_branch L_back17
L_stub18:
  s_call_b64 s[60:61], L_slowA
  s_branch L_back18
L_stub19:
  s_call_b64 s[60:61], L_slowB
  s_branch L_back19
L_stub20:
  s_call_b64 s[60:61], L_slowA
  s_branch L_back20
L_stub21:
  s_call_b64 s[60:61], L_slowB
  s_branch L_back21
L_stub22:
  s_call_b64 s[60:61], L_slowA
  s_branch L_back22
L_stub23:
  s_call_b64 s[60:61], L_slowB
  s_branch L_back23
L_slowA:
  v_max3_f32 v0, v128, v129, v130
  v_max3_f32 v1, v131, v132, v133
  v_max3_f32 v0, v0, v134, v135
  v_max_f32 v0, v0, v1
  v_mov_b32 v1, v0
  s_nop 1
  v_permlane16_swap_b32 v0, v1
  s_nop 1
  v_max_f32 v0, v0, v1
  v_mov_b32 v1, v0
  s_nop 1
  v_permlane32_swap_b32 v0, v1
  s_nop 1
  v_max_f32 v0, v0, v1
  v_add_f32 v3, 0x41200000, v0
  v_max_f32 v3, 0, v3
  v_add_f32 v216, v216, v3
  v_exp_f32 v4, -v3
  v_sub_f32 v5, 0, v216
  v_mov_b32 v160, v5
  v_mov_b32 v161, v5
  v_mov_b32 v162, v5
  v_mov_b32 v163, v5
  v_mul_f32 v200, v200, v4
  v_mul_f32 v64, v64, v4
  v_mul_f32 v65, v65, v4
  v_mul_f32 v66, v66, v4
  v_mul_f32 v67, v67, v4
  v_mul_f32 v68, v68, v4
  v_mul_f32 v69, v69, v4
  v_mul_f32 v70, v70, v4
  v_mul_f32 v71, v71, v4
  v_mul_f32 v72, v72, v4
  v_mul_f32 v73, v73, v4
  v_mul_f32 v74, v74, v4
  v_mul_f32 v75, v75, v4
  v_mul_f32 v76, v76, v4
  v_mul_f32 v77, v77, v4
  v_mul_f32 v78, v78, v4
  v_mul_f32 v79, v79, v4
  v_mul_f32 v80, v80, v4
  v_mul_f32 v81, v81, v4
  v_mul_f32 v82, v82, v4
  v_mul_f32 v83, v83, v4
  v_mul_f32 v84, v84, v4
  v_mul_f32 v85, v85, v4
  v_mul_f32 v86, v86, v4
  v_mul_f32 v87, v87, v4
  v_mul_f32 v88, v88, v4
  v_mul_f32 v89, v89, v4
  v_mul_f32 v90, v90, v4
  v_mul_f32 v91, v91, v4
  v_mul_f32 v92, v92, v4
  v_mul_f32 v93, v93, v4
  v_mul_f32 v94, v94, v4
  v_mul_f32 v95, v95, v4
  v_sub_f32 v8, v128, v3
  v_sub_f32 v9, v129, v3
  v_sub_f32 v10, v130, v3
  v_sub_f32 v11, v131, v3
  v_exp_f32 v8, v8
  v_exp_f32 v9, v9
  v_exp_f32 v10, v10
  v_exp_f32 v11, v11
  s_nop 0
  v_cvt_pk_bf16_f32 v176, v8, v9
  v_cvt_pk_bf16_f32 v177, v10, v11
  v_sub_f32 v8, v132, v3
  v_sub_f32 v9, v133, v3
  v_sub_f32 v10, v134, v3
  v_sub_f32 v11, v135, v3
  v_exp_f32 v8, v8
  v_exp_f32 v9, v9
  v_exp_f32 v10, v10
  v_exp_f32 v11, v11
  s_nop 0
  v_cvt_pk_bf16_f32 v178, v8, v9
  v_cvt_pk_bf16_f32 v179, v10, v11
  v_max3_f32 v0, v136, v137, v138
  v_max3_f32 v1, v139, v140, v141
  v_max3_f32 v0, v0, v142, v143
  v_max_f32 v0, v0, v1
  v_mov_b32 v1, v0
  s_nop 1
  v_permlane16_swap_b32 v0, v1
  s_nop 1
  v_max_f32 v0, v0, v1
  v_mov_b32 v1, v0
  s_nop 1
  v_permlane32_swap_b32 v0, v1
  s_nop 1
  v_max_f32 v0, v0, v1
  v_add_f32 v3, 0x41200000, v0
  v_max_f32 v3, 0, v3
  v_add_f32 v217, v217, v3
  v_exp_f32 v4, -v3
  v_sub_f32 v5, 0, v217
  v_mov_b32 v164, v5
  v_mov_b32 v165, v5
  v_mov_b32 v166, v5
  v_mov_b32 v167, v5
  v_mul_f32 v204, v204, v4
  v_mul_f32 v96, v96, v4
  v_mul_f32 v97, v97, v4
  v_mul_f32 v98, v98, v4
  v_mul_f32 v99, v99, v4
  v_mul_f32 v100, v100, v4
  v_mul_f32 v101, v101, v4
  v_mul_f32 v102, v102, v4
  v_mul_f32 v103, v103, v4
  v_mul_f32 v104, v104, v4
  v_mul_f32 v105, v105, v4
  v_mul_f32 v106, v106, v4
  v_mul_f32 v107, v107, v4
  v_mul_f32 v108, v108, v4
  v_mul_f32 v109, v109, v4
  v_mul_f32 v110, v110, v4
  v_mul_f32 v111, v111, v4
  v_mul_f32 v112, v112, v4
  v_mul_f32 v113, v113, v4
  v_mul_f32 v114, v114, v4
  v_mul_f32 v115, v115, v4
  v_mul_f32 v116, v116, v4
  v_mul_f32 v117, v117, v4
  v_mul_f32 v118, v118, v4
  v_mul_f32 v119, v119, v4
  v_mul_f32 v120, v120, v4
  v_mul_f32 v121, v121, v4
  v_mul_f32 v122, v122, v4
  v_mul_f32 v123, v123, v4
  v_mul_f32 v124, v124, v4
  v_mul_f32 v125, v125, v4
  v_mul_f32 v126, v126, v4
  v_mul_f32 v127, v127, v4
  v_sub_f32 v8, v136, v3
  v_sub_f32 v9, v137, v3
  v_sub_f32 v10, v138, v3
  v_sub_f32 v11, v139, v3
  v_exp_f32 v8, v8
  v_exp_f32 v9, v9
  v_exp_f32 v10, v10
  v_exp_f32 v11, v11
  s_nop 0
  v_cvt_pk_bf16_f32 v180, v8, v9
  v_cvt_pk_bf16_f32 v181, v10, v11
  v_sub_f32 v8, v140, v3
  v_sub_f32 v9, v141, v3
  v_sub_f32 v10, v142, v3
  v_sub_f32 v11, v143, v3
  v_exp_f32 v8, v8
  v_exp_f32 v9, v9
  v_exp_f32 v10, v10
  v_exp_f32 v11, v11
  s_nop 0
  v_cvt_pk_bf16_f32 v182, v8, v9
  v_cvt_pk_bf16_f32 v183, v10, v11
  s_nop 1
  s_setpc_b64 s[60:61]
L_slowB:
  v_max3_f32 v0, v144, v145, v146
  v_max3_f32 v1, v147, v148, v149
  v_max3_f32 v0, v0, v150, v151
  v_max_f32 v0, v0, v1
  v_mov_b32 v1, v0
  s_nop 1
  v_permlane16_swap_b32 v0, v1
  s_nop 1
  v_max_f32 v0, v0, v1
  v_mov_b32 v1, v0
  s_nop 1
  v_permlane32_swap_b32 v0, v1
  s_nop 1
  v_max_f32 v0, v0, v1
  v_add_f32 v3, 0x41200000, v0
  v_max_f32 v3, 0, v3
  v_add_f32 v218, v218, v3
  v_exp_f32 v4, -v3
  v_sub_f32 v5, 0, v218
  v_mov_b32 v168, v5
  v_mov_b32 v169, v5
  v_mov_b32 v170, v5
  v_mov_b32 v171, v5
  v_mul_f32 v208, v208, v4
  v_accvgpr_read_b32 v8, a0
  v_accvgpr_read_b32 v9, a1
  v_accvgpr_read_b32 v10, a2
  v_accvgpr_read_b32 v11, a3
  v_mul_f32 v8, v8, v4
  v_mul_f32 v9, v9, v4
  v_mul_f32 v10, v10, v4
  v_mul_f32 v11, v11, v4
  v_accvgpr_write_b32 a0, v8
  v_accvgpr_write_b32 a1, v9
  v_accvgpr_write_b32 a2, v10
  v_accvgpr_write_b32 a3, v11
  v_accvgpr_read_b32 v8, a4
  v_accvgpr_read_b32 v9, a5
  v_accvgpr_read_b32 v10, a6
  v_accvgpr_read_b32 v11, a7
  v_mul_f32 v8, v8, v4
  v_mul_f32 v9, v9, v4
  v_mul_f32 v10, v10, v4
  v_mul_f32 v11, v11, v4
  v_accvgpr_write_b32 a4, v8
  v_accvgpr_write_b32 a5, v9
  v_accvgpr_write_b32 a6, v10
  v_accvgpr_write_b32 a7, v11
  v_accvgpr_read_b32 v8, a8
  v_accvgpr_read_b32 v9, a9
  v_accvgpr_read_b32 v10, a10
  v_accvgpr_read_b32 v11, a11
  v_mul_f32 v8, v8, v4
  v_mul_f32 v9, v9, v4
  v_mul_f32 v10, v10, v4
  v_mul_f32 v11, v11, v4
  v_accvgpr_write_b32 a8, v8
  v_accvgpr_write_b32 a9, v9
  v_accvgpr_write_b32 a10, v10
  v_accvgpr_write_b32 a11, v11
  v_accvgpr_read_b32 v8, a12
  v_accvgpr_read_b32 v9, a13
  v_accvgpr_read_b32 v10, a14
  v_accvgpr_read_b32 v11, a15
  v_mul_f32 v8, v8, v4
  v_mul_f32 v9, v9, v4
  v_mul_f32 v10, v10, v4
  v_mul_f32 v11, v11, v4
  v_accvgpr_write_b32 a12, v8
  v_accvgpr_write_b32 a13, v9
  v_accvgpr_write_b32 a14, v10
  v_accvgpr_write_b32 a15, v11
  v_accvgpr_read_b32 v8, a16
  v_accvgpr_read_b32 v9, a17
  v_accvgpr_read_b32 v10, a18
  v_accvgpr_read_b32 v11, a19
  v_mul_f32 v8, v8, v4
  v_mul_f32 v9, v9, v4
  v_mul_f32 v10, v10, v4
  v_mul_f32 v11, v11, v4
  v_accvgpr_write_b32 a16, v8
  v_accvgpr_write_b32 a17, v9
  v_accvgpr_write_b32 a18, v10
  v_accvgpr_write_b32 a19, v11
  v_accvgpr_read_b32 v8, a20
  v_accvgpr_read_b32 v9, a21
  v_accvgpr_read_b32 v10, a22
  v_accvgpr_read_b32 v11, a23
  v_mul_f32 v8, v8, v4
  v_mul_f32 v9, v9, v4
  v_mul_f32 v10, v10, v4
  v_mul_f32 v11, v11, v4
  v_accvgpr_write_b32 a20, v8
  v_accvgpr_write_b32 a21, v9
  v_accvgpr_write_b32 a22, v10
  v_accvgpr_write_b32 a23, v11
  v_accvgpr_read_b32 v8, a24
  v_accvgpr_read_b32 v9, a25
  v_accvgpr_read_b32 v10, a26
  v_accvgpr_read_b32 v11, a27
  v_mul_f32 v8, v8, v4
  v_mul_f32 v9, v9, v4
  v_mul_f32 v10, v10, v4
  v_mul_f32 v11, v11, v4
  v_accvgpr_write_b32 a24, v8
  v_accvgpr_write_b32 a25, v9
  v_accvgpr_write_b32 a26, v10
  v_accvgpr_write_b32 a27, v11
  v_accvgpr_read_b32 v8, a28
  v_accvgpr_read_b32 v9, a29
  v_accvgpr_read_b32 v10, a30
  v_accvgpr_read_b32 v11, a31
  v_mul_f32 v8, v8, v4
  v_mul_f32 v9, v9, v4
  v_mul_f32 v10, v10, v4
  v_mul_f32 v11, v11, v4
  v_accvgpr_write_b32 a28, v8
  v_accvgpr_write_b32 a29, v9
  v_accvgpr_write_b32 a30, v10
  v_accvgpr_write_b32 a31, v11
  v_sub_f32 v8, v144, v3
  v_sub_f32 v9, v145, v3
  v_sub_f32 v10, v146, v3
  v_sub_f32 v11, v147, v3
  v_exp_f32 v8, v8
  v_exp_f32 v9, v9
  v_exp_f32 v10, v10
  v_exp_f32 v11, v11
  s_nop 0
  v_cvt_pk_bf16_f32 v184, v8, v9
  v_cvt_pk_bf16_f32 v185, v10, v11
  v_sub_f32 v8, v148, v3
  v_sub_f32 v9, v149, v3
  v_sub_f32 v10, v150, v3
  v_sub_f32 v11, v151, v3
  v_exp_f32 v8, v8
  v_exp_f32 v9, v9
  v_exp_f32 v10, v10
  v_exp_f32 v11, v11
  s_nop 0
  v_cvt_pk_bf16_f32 v186, v8, v9
  v_cvt_pk_bf16_f32 v187, v10, v11
  v_max3_f32 v0, v152, v153, v154
  v_max3_f32 v1, v155, v156, v157
  v_max3_f32 v0, v0, v158, v159
  v_max_f32 v0, v0, v1
  v_mov_b32 v1, v0
  s_nop 1
  v_permlane16_swap_b32 v0, v1
  s_nop 1
  v_max_f32 v0, v0, v1
  v_mov_b32 v1, v0
  s_nop 1
  v_permlane32_swap_b32 v0, v1
  s_nop 1
  v_max_f32 v0, v0, v1
  v_add_f32 v3, 0x41200000, v0
  v_max_f32 v3, 0, v3
  v_add_f32 v219, v219, v3
  v_exp_f32 v4, -v3
  v_sub_f32 v5, 0, v219
  v_mov_b32 v172, v5
  v_mov_b32 v173, v5
  v_mov_b32 v174, v5
  v_mov_b32 v175, v5
  v_mul_f32 v212, v212, v4
  v_accvgpr_read_b32 v8, a32
  v_accvgpr_read_b32 v9, a33
  v_accvgpr_read_b32 v10, a34
  v_accvgpr_read_b32 v11, a35
  v_mul_f32 v8, v8, v4
  v_mul_f32 v9, v9, v4
  v_mul_f32 v10, v10, v4
  v_mul_f32 v11, v11, v4
  v_accvgpr_write_b32 a32, v8
  v_accvgpr_write_b32 a33, v9
  v_accvgpr_write_b32 a34, v10
  v_accvgpr_write_b32 a35, v11
  v_accvgpr_read_b32 v8, a36
  v_accvgpr_read_b32 v9, a37
  v_accvgpr_read_b32 v10, a38
  v_accvgpr_read_b32 v11, a39
  v_mul_f32 v8, v8, v4
  v_mul_f32 v9, v9, v4
  v_mul_f32 v10, v10, v4
  v_mul_f32 v11, v11, v4
  v_accvgpr_write_b32 a36, v8
  v_accvgpr_write_b32 a37, v9
  v_accvgpr_write_b32 a38, v10
  v_accvgpr_write_b32 a39, v11
  v_accvgpr_read_b32 v8, a40
  v_accvgpr_read_b32 v9, a41
  v_accvgpr_read_b32 v10, a42
  v_accvgpr_read_b32 v11, a43
  v_mul_f32 v8, v8, v4
  v_mul_f32 v9, v9, v4
  v_mul_f32 v10, v10, v4
  v_mul_f32 v11, v11, v4
  v_accvgpr_write_b32 a40, v8
  v_accvgpr_write_b32 a41, v9
  v_accvgpr_write_b32 a42, v10
  v_accvgpr_write_b32 a43, v11
  v_accvgpr_read_b32 v8, a44
  v_accvgpr_read_b32 v9, a45
  v_accvgpr_read_b32 v10, a46
  v_accvgpr_read_b32 v11, a47
  v_mul_f32 v8, v8, v4
  v_mul_f32 v9, v9, v4
  v_mul_f32 v10, v10, v4
  v_mul_f32 v11, v11, v4
  v_accvgpr_write_b32 a44, v8
  v_accvgpr_write_b32 a45, v9
  v_accvgpr_write_b32 a46, v10
  v_accvgpr_write_b32 a47, v11
  v_accvgpr_read_b32 v8, a48
  v_accvgpr_read_b32 v9, a49
  v_accvgpr_read_b32 v10, a50
  v_accvgpr_read_b32 v11, a51
  v_mul_f32 v8, v8, v4
  v_mul_f32 v9, v9, v4
  v_mul_f32 v10, v10, v4
  v_mul_f32 v11, v11, v4
  v_accvgpr_write_b32 a48, v8
  v_accvgpr_write_b32 a49, v9
  v_accvgpr_write_b32 a50, v10
  v_accvgpr_write_b32 a51, v11
  v_accvgpr_read_b32 v8, a52
  v_accvgpr_read_b32 v9, a53
  v_accvgpr_read_b32 v10, a54
  v_accvgpr_read_b32 v11, a55
  v_mul_f32 v8, v8, v4
  v_mul_f32 v9, v9, v4
  v_mul_f32 v10, v10, v4
  v_mul_f32 v11, v11, v4
  v_accvgpr_write_b32 a52, v8
  v_accvgpr_write_b32 a53, v9
  v_accvgpr_write_b32 a54, v10
  v_accvgpr_write_b32 a55, v11
  v_accvgpr_read_b32 v8, a56
  v_accvgpr_read_b32 v9, a57
  v_accvgpr_read_b32 v10, a58
  v_accvgpr_read_b32 v11, a59
  v_mul_f32 v8, v8, v4
  v_mul_f32 v9, v9, v4
  v_mul_f32 v10, v10, v4
  v_mul_f32 v11, v11, v4
  v_accvgpr_write_b32 a56, v8
  v_accvgpr_write_b32 a57, v9
  v_accvgpr_write_b32 a58, v10
  v_accvgpr_write_b32 a59, v11
  v_accvgpr_read_b32 v8, a60
  v_accvgpr_read_b32 v9, a61
  v_accvgpr_read_b32 v10, a62
  v_accvgpr_read_b32 v11, a63
  v_mul_f32 v8, v8, v4
  v_mul_f32 v9, v9, v4
  v_mul_f32 v10, v10, v4
  v_mul_f32 v11, v11, v4
  v_accvgpr_write_b32 a60, v8
  v_accvgpr_write_b32 a61, v9
  v_accvgpr_write_b32 a62, v10
  v_accvgpr_write_b32 a63, v11
  v_sub_f32 v8, v152, v3
  v_sub_f32 v9, v153, v3
  v_sub_f32 v10, v154, v3
  v_sub_f32 v11, v155, v3
  v_exp_f32 v8, v8
  v_exp_f32 v9, v9
  v_exp_f32 v10, v10
  v_exp_f32 v11, v11
  s_nop 0
  v_cvt_pk_bf16_f32 v188, v8, v9
  v_cvt_pk_bf16_f32 v189, v10, v11
  v_sub_f32 v8, v156, v3
  v_sub_f32 v9, v157, v3
  v_sub_f32 v10, v158, v3
  v_sub_f32 v11, v159, v3
  v_exp_f32 v8, v8
  v_exp_f32 v9, v9
  v_exp_f32 v10, v10
  v_exp_f32 v11, v11
  s_nop 0
  v_cvt_pk_bf16_f32 v190, v8, v9
  v_cvt_pk_bf16_f32 v191, v10, v11
  s_nop 1
  s_setpc_b64 s[60:61]
L_codeend:
.section .rodata,"a"
.p2align 6
.amdhsa_kernel standalone__tree_speculative_verify_tree_attention_over_candidate_token_tree__sampling_kernel
  .amdhsa_next_free_vgpr 512
  .amdhsa_next_free_sgpr 102
  .amdhsa_accum_offset 256
  .amdhsa_group_segment_fixed_size 0
  .amdhsa_kernarg_size 72
  .amdhsa_user_sgpr_count 2
  .amdhsa_user_sgpr_kernarg_segment_ptr 1
  .amdhsa_system_sgpr_workgroup_id_x 1
.end_amdhsa_kernel
```
